```python
import torch

def _softmax(x, axis=-1):
    return torch.softmax(x, dim=axis)
def _gelu(x):
    return torch.nn.functional.gelu(x, approximate="tanh")
def _silu(x):
    return torch.nn.functional.silu(x)
def _sigmoid(x):
    return torch.sigmoid(x)
def _layernorm(x, axis=-1, eps=1e-5):
    m = x.mean(dim=axis, keepdim=True)
    v = x.var(dim=axis, keepdim=True, unbiased=False)
    return (x - m) / torch.sqrt(v + eps)
def _scatter_add(tgt, idx, src, axis=0):
    return tgt.clone().index_add_(axis, idx, src)
def _segment_sum(src, seg, n):
    out = torch.zeros((n,) + src.shape[1:], dtype=src.dtype)
    return out.index_add_(0, seg, src)
def _pad(x, pw):
    flat = tuple(v for pair in reversed(pw) for v in pair)
    return torch.nn.functional.pad(x, flat)

kernel_name = 'concat_heads__sliding_local_dilated__mha_block__prompt'

def setup_inputs():

    _w = (lambda a: (lambda t: t.to(torch.bfloat16) if t.is_floating_point() else t)(torch.as_tensor(a)))
    def _A_setup():
        B, S, D = 1, 2048, 448
        return {
            "x": _w((lambda *s: torch.randn(*s, dtype=torch.bfloat16) * 0.4)(B, S, D)),
            "wqkv": _w((lambda *s: torch.randn(*s, dtype=torch.bfloat16) * 0.8)(D, 3 * D)),
            "wo": _w((lambda *s: torch.randn(*s, dtype=torch.bfloat16) * 0.1)(D, D)),
        }
    _A_in = _A_setup()

    def _B_setup():
        B, S, D, H = 1, 2048, 448, 16
        return {
            "x": _w((lambda *s: torch.randn(*s, dtype=torch.bfloat16) * 0.2)(B, S, D)),
            "wqkv": _w((lambda *s: torch.randn(*s, dtype=torch.bfloat16) * 0.8)(D, 3 * D)),
            "wo": _w((lambda *s: torch.randn(*s, dtype=torch.bfloat16) * 0.2)(D, D)),
        }
    _B_in = _B_setup()

    return {
        "A_x": _A_in["x"],
        "A_wqkv": _A_in["wqkv"],
        "A_wo": _A_in["wo"],
        "B_x": _B_in["x"],
        "B_wqkv": _B_in["wqkv"],
        "B_wo": _B_in["wo"],
    }

def reference(A_x, A_wqkv, A_wo, B_x, B_wqkv, B_wo):
    def _A_ref(x, wqkv, wo):
        B, S, D = x.shape
        H = 16; Dh = D // H
        W, dil = 8, 2
        qkv = (lambda x, *d: x.permute(*d))((x @ wqkv).reshape(B, S, 3, H, Dh), 2, 0, 3, 1, 4)
        q, k, v = qkv[0], qkv[1], qkv[2]
        scale = Dh ** -0.5
        pos = torch.arange(S)
        off = torch.arange(W) * dil
        idx = pos[:, None] - off[None, :]
        mask = idx >= 0
        idx_c = torch.where(mask, idx, 0).reshape(-1)
        kg = k[:, :, idx_c, :].reshape(B, H, S, W, Dh)
        vg = v[:, :, idx_c, :].reshape(B, H, S, W, Dh)
        logits = torch.einsum("bhsd,bhswd->bhsw", q, kg) * scale
        logits = torch.where(mask[None, None, :, :], logits, -1e9)
        attn = _softmax(logits, axis=-1)
        o = torch.einsum("bhsw,bhswd->bhsd", attn, vg)
        return (lambda x, *d: x.permute(*d))(o, 0, 2, 1, 3).reshape(B, S, D) @ wo

    def _B_ref(x, wqkv, wo):
        B, S, D = x.shape
        H = 16
        Dh = D // H
        qkv = (lambda x, *d: x.permute(*d))((x @ wqkv).reshape(B, S, 3, H, Dh), 2, 0, 3, 1, 4)
        q, k, v = qkv[0], qkv[1], qkv[2]
        scores = torch.einsum("bhqd,bhkd->bhqk", q, k) * (Dh ** -0.5)
        p = _softmax(scores, axis=-1)
        o = torch.einsum("bhqk,bhkd->bhqd", p, v)
        return (lambda x, *d: x.permute(*d))(o, 0, 2, 1, 3).reshape(B, S, D) @ wo

    a = _A_ref(A_x, A_wqkv, A_wo)
    b = _B_ref(B_x, B_wqkv, B_wo)
    return torch.concatenate([a, b], axis=-1)
```

```asm
; @launch grid=(256,1,1) block=(768,1,1) lds=163840
.amdgcn_target "amdgcn-amd-amdhsa--gfx950"
.text
.globl concat_heads__sliding_local_dilated__mha_block__prompt_kernel
.p2align 8
.type concat_heads__sliding_local_dilated__mha_block__prompt_kernel,@function
concat_heads__sliding_local_dilated__mha_block__prompt_kernel:
    s_load_dwordx16 s[4:19], s[0:1], 0
    s_load_dwordx2 s[20:21], s[0:1], 64
    s_cmp_ge_u32 s2, 256
    s_cbranch_scc1 L_end
    v_lshrrev_b32 v1, 6, v0
    v_and_b32 v0, 63, v0
    s_and_b32 s53, s2, 7
    v_readfirstlane_b32 s52, v1
    s_lshr_b32 s54, s2, 3
    s_nop 1
    s_and_b32 s76, s52, 3
    s_lshr_b32 s77, s52, 2
    s_cmp_lt_u32 s52, 2
    s_cbranch_scc1 L_gemm
    s_cmp_lt_u32 s52, 4
    s_cbranch_scc1 L_pad0
    s_cmp_lt_u32 s52, 6
    s_cbranch_scc1 L_pad1
    s_cmp_lt_u32 s52, 8
    s_cbranch_scc1 L_pad2
    s_setprio 3
    v_lshrrev_b32 v8, 3, v0
    v_and_b32 v9, 7, v0
    v_lshrrev_b32 v10, 4, v0
    s_lshl_b32 s3, s76, 4
    v_add_u32 v8, s3, v8
    v_mul_u32_u24 v6, 2688, v8
    v_mul_u32_u24 v8, 896, v8
    v_xor_b32 v4, v9, v10
    v_lshlrev_b32 v4, 4, v4
    v_add_u32 v4, v8, v4
    v_add_u32 v5, 7168, v4
    v_xor_b32 v5, 64, v5
    v_and_b32 v8, 1, v10
    v_lshlrev_b32 v8, 2, v8
    v_xor_b32 v8, v8, v9
    v_lshlrev_b32 v8, 4, v8
    v_add_u32 v6, v6, v8
    s_lshr_b32 s55, s53, 1
    s_lshl_b32 s55, s55, 3
    s_and_b32 s3, s54, 7
    s_add_u32 s55, s55, s3
    s_xor_b32 s3, s53, 0
    s_and_b32 s3, s3, 1
    s_lshl_b32 s3, s3, 2
    s_lshr_b32 s56, s54, 3
    s_add_u32 s56, s56, s3
    s_cmp_lt_u32 s56, 7
    s_cselect_b32 s57, 1, 0
    s_cmp_lg_u32 0, 0
L_pad0:
    s_cbranch_scc1 L_gemm
    s_cmp_lg_u32 s57, 0
    s_cselect_b32 s68, 1835008, 0
    s_cselect_b32 s69, 1204224, 0
    s_mul_i32 s73, s55, 57344
    s_lshl_b32 s72, s56, 7
    s_add_u32 s40, s55, s56
    s_and_b32 s40, s40, 3
    s_lshl_b32 s40, s40, 1
    s_add_u32 s40, s40, s53
    s_cmp_ge_u32 s40, 7
    s_cselect_b32 s3, 7, 0
    s_sub_u32 s40, s40, s3
    s_lshl_b32 s75, s76, 11
    s_mov_b32 s74, 0
    s_waitcnt lgkmcnt(0)
    s_mov_b32 s28, s10
    s_and_b32 s29, s11, 0xffff
    s_mov_b32 s30, s68
    s_mov_b32 s31, 0x20000
    s_mov_b32 s32, s12
    s_and_b32 s33, s13, 0xffff
    s_mov_b32 s34, s69
    s_mov_b32 s35, 0x20000
    s_cmp_lg_u32 0, 0
L_pad1:
    s_cbranch_scc1 L_gemm
    s_lshl_b32 s68, s40, 7
    s_mov_b32 m0, s75
    s_add_u32 s68, s68, s73
    s_mul_i32 s69, s40, 172032
    buffer_load_dwordx4 v4, s[28:31], s68 offen lds
    s_add_u32 m0, s75, 1024
    s_add_u32 s69, s69, s72
    buffer_load_dwordx4 v5, s[28:31], s68 offen lds
    s_add_u32 m0, s75, 16384
    s_add_u32 s68, s69, 896
    buffer_load_dwordx4 v6, s[32:35], s68 offen lds
    s_add_u32 s40, s40, 1
    s_add_u32 m0, s75, 17408
    s_add_u32 s68, s69, 22400
    buffer_load_dwordx4 v6, s[32:35], s68 offen lds
    s_cmp_eq_u32 s40, 7
    s_cselect_b32 s40, 0, s40
    s_add_u32 m0, s75, 24576
    s_add_u32 s68, s69, 1792
    buffer_load_dwordx4 v6, s[32:35], s68 offen lds
    s_cmp_lg_u32 0, 0
L_pad2:
    s_cbranch_scc1 L_gemm
    s_add_u32 m0, s75, 25600
    s_add_u32 s68, s69, 23296
    buffer_load_dwordx4 v6, s[32:35], s68 offen lds
    s_add_u32 m0, s75, 8192
    s_add_u32 s68, s69, 0
    buffer_load_dwordx4 v6, s[32:35], s68 offen lds
    s_add_u32 m0, s75, 9216
    s_add_u32 s68, s69, 21504
    buffer_load_dwordx4 v6, s[32:35], s68 offen lds
    s_add_u32 s75, s75, 32768
    s_mov_b32 s74, 1
    s_lshr_b32 s63, s54, 2
    s_min_u32 s63, s63, 6
    s_and_b32 s3, s54, 3
    s_lshl_b32 s62, s53, 2
    s_add_u32 s62, s62, s3
    s_lshl_b32 s58, s53, 1
    s_lshr_b32 s61, s54, 4
    s_add_u32 s58, s58, s61
    s_and_b32 s59, s54, 15
    s_mul_i32 s60, s58, 7
    s_lshr_b32 s60, s60, 1
    s_cmp_eq_u32 s61, 0
    s_cselect_b32 s66, 0x0fffffff, 0xfffffff0
    s_mov_b32 s67, s66
    v_lshlrev_b32 v2, 4, v0
    s_and_b32 s51, s63, 1
    s_xor_b32 s51, s51, 1
    s_add_u32 s78, s76, 4
    s_lshl_b32 s3, s59, 2
    s_add_u32 s3, s3, s76
    s_mul_i32 s3, s3, 28672
    s_lshl_b32 s50, s60, 9
    s_add_u32 s50, s50, s3
    s_add_u32 s50, s50, 12845056
    v_add_u32 v148, 139264, v2
    v_add_u32 v149, 106496, v2
    v_add_u32 v150, 8192, v2
    v_add_u32 v152, 131072, v2
    s_lshl_b32 s3, s76, 11
    s_add_u32 s3, s3, 65536
    v_add_u32 v151, s3, v2
    s_lshl_b32 s3, s76, 10
    v_add_u32 v160, s3, v2
    v_add_u32 v153, 61440, v160
    v_add_u32 v156, 57344, v160
    v_add_u32 v154, 106496, v160
    v_add_u32 v157, 98304, v160
    v_lshrrev_b32 v160, 2, v160
    v_add_u32 v155, 110592, v160
    v_add_u32 v158, 102400, v160
    v_lshrrev_b32 v160, 4, v0
    v_lshrrev_b32 v161, 2, v0
    v_and_b32 v161, 3, v161
    v_lshlrev_b32 v162, 3, v160
    v_add_u32 v162, v162, v161
    v_lshlrev_b32 v162, 7, v162
    v_and_b32 v161, 2, v161
    v_and_b32 v163, 1, v160
    v_or_b32 v161, v161, v163
    v_lshlrev_b32 v161, 5, v161
    v_add_u32 v162, v162, v161
    v_and_b32 v161, 3, v0
    v_lshlrev_b32 v161, 3, v161
    v_add_u32 v162, v162, v161
    s_mul_i32 s3, s51, 28672
    v_add_u32 v164, s3, v162
    s_lshl_b32 s3, s51, 6
    v_xor_b32 v164, s3, v164
    v_xor_b32 v165, 32, v164
    v_xor_b32 v166, 64, v164
    v_xor_b32 v167, 96, v164
    s_lshl_b32 s49, s62, 1
    s_lshr_b32 s3, s76, 1
    s_add_u32 s49, s49, s3
    s_mul_i32 s49, s49, 28672
    s_and_b32 s3, s76, 1
    s_lshl_b32 s3, s3, 8
    s_add_u32 s49, s49, s3
    s_mul_i32 s3, s51, 14336
    s_add_u32 s49, s49, s3
    s_add_u32 s49, s49, 12845056
    v_and_b32 v161, 15, v0
    v_lshlrev_b32 v162, 9, v160
    v_lshlrev_b32 v159, 4, v161
    v_add_u32 v162, v162, v159
    s_lshl_b32 s3, s62, 2
    s_add_u32 s3, s3, s76
    s_lshl_b32 s3, s3, 4
    v_add_u32 v161, s3, v161
    v_mul_u32_u24 v161, 1792, v161
    v_lshlrev_b32 v163, 5, v163
    v_add_u32 v161, v161, v163
    v_lshrrev_b32 v163, 1, v160
    v_lshlrev_b32 v163, 4, v163
    v_add_u32 v161, v161, v163
    s_lshl_b32 s48, s63, 7
    s_lshl_b32 s3, s51, 6
    s_add_u32 s48, s48, s3
    s_add_u32 s48, s48, 896
    v_mov_b32 v104, 0
    v_mov_b32 v105, 0
    v_mov_b32 v106, 0
    v_mov_b32 v107, 0
    v_mov_b32 v108, 0
    v_mov_b32 v109, 0
    v_mov_b32 v110, 0
    v_mov_b32 v111, 0
    v_mov_b32 v112, 0
    v_mov_b32 v113, 0
    v_mov_b32 v114, 0
    v_mov_b32 v115, 0
    v_mov_b32 v116, 0
    v_mov_b32 v117, 0
    v_mov_b32 v118, 0
    v_mov_b32 v119, 0
    v_mov_b32 v64, 0
    v_mov_b32 v65, 0
    v_mov_b32 v66, 0
    v_mov_b32 v67, 0
    v_mov_b32 v132, 0
    v_mov_b32 v133, 0
    v_mov_b32 v134, 0
    v_mov_b32 v135, 0
    s_mov_b32 s24, s20
    s_and_b32 s25, s21, 0xffff
    s_mov_b32 s26, 0xe49000
    s_mov_b32 s27, 0x20000
    s_mov_b32 s36, s16
    s_and_b32 s37, s17, 0xffff
    s_mov_b32 s38, 0x380000
    s_mov_b32 s39, 0x20000
    s_mov_b32 s77, 1
    s_cmp_lg_u32 s57, 0
    s_cbranch_scc1 H1_loop
    s_barrier
    s_branch H1_sw
H1_loop:
    s_lshl_b32 s68, s40, 7
    s_mov_b32 m0, s75
    s_add_u32 s68, s68, s73
    s_mul_i32 s69, s40, 172032
    buffer_load_dwordx4 v4, s[28:31], s68 offen lds
    s_add_u32 m0, s75, 1024
    s_add_u32 s69, s69, s72
    buffer_load_dwordx4 v5, s[28:31], s68 offen lds
    s_add_u32 m0, s75, 16384
    s_add_u32 s68, s69, 896
    buffer_load_dwordx4 v6, s[32:35], s68 offen lds
    s_add_u32 s40, s40, 1
    s_add_u32 m0, s75, 17408
    s_add_u32 s68, s69, 22400
    buffer_load_dwordx4 v6, s[32:35], s68 offen lds
    s_cmp_eq_u32 s40, 7
    s_cselect_b32 s40, 0, s40
    s_add_u32 m0, s75, 24576
    s_add_u32 s68, s69, 1792
    buffer_load_dwordx4 v6, s[32:35], s68 offen lds
    s_add_u32 s74, s74, 1
    s_add_u32 m0, s75, 25600
    s_add_u32 s68, s69, 23296
    buffer_load_dwordx4 v6, s[32:35], s68 offen lds
    s_add_u32 m0, s75, 8192
    s_add_u32 s68, s69, 0
    buffer_load_dwordx4 v6, s[32:35], s68 offen lds
    s_add_u32 m0, s75, 9216
    s_add_u32 s68, s69, 21504
    buffer_load_dwordx4 v6, s[32:35], s68 offen lds
    s_add_u32 s75, s75, 32768
    s_and_b32 s75, s75, 131071
    s_waitcnt vmcnt(8)
    s_barrier
    s_cmp_lg_u32 s74, 7
    s_cbranch_scc1 H1_same
H1_sw:
    s_lshr_b32 s55, s53, 1
    s_lshl_b32 s55, s55, 3
    s_and_b32 s3, s54, 7
    s_add_u32 s55, s55, s3
    s_xor_b32 s3, s53, 1
    s_and_b32 s3, s3, 1
    s_lshl_b32 s3, s3, 2
    s_lshr_b32 s56, s54, 3
    s_add_u32 s56, s56, s3
    s_cmp_lt_u32 s56, 7
    s_cselect_b32 s57, 1, 0
    s_cmp_lg_u32 s57, 0
    s_cselect_b32 s68, 1835008, 0
    s_cselect_b32 s69, 1204224, 0
    s_mul_i32 s73, s55, 57344
    s_lshl_b32 s72, s56, 7
    s_xor_b32 s40, s55, s56
    s_and_b32 s40, s40, 1
    s_mul_i32 s40, s40, 3
    s_add_u32 s40, s40, s53
    s_cmp_ge_u32 s40, 7
    s_cselect_b32 s3, 7, 0
    s_sub_u32 s40, s40, s3
    s_mov_b32 s28, s4
    s_and_b32 s29, s5, 0xffff
    s_mov_b32 s30, s68
    s_mov_b32 s31, 0x20000
    s_mov_b32 s32, s6
    s_and_b32 s33, s7, 0xffff
    s_mov_b32 s34, s69
    s_mov_b32 s35, 0x20000
    s_add_u32 s40, s40, 1
    s_cmp_eq_u32 s40, 7
    s_cselect_b32 s40, 0, s40
    s_lshl_b32 s75, s76, 11
    s_mov_b32 s74, 8
H1_same:
    s_cmp_lt_u32 s74, 14
    s_cbranch_scc1 H1_loop
    s_waitcnt vmcnt(0)
    s_barrier
    s_branch C_attn
C_bb:
    s_cmp_lg_u32 s57, 0
    s_cbranch_scc1 C_b0
    s_barrier
    s_barrier
    s_branch C_pub
L_gemm:
    v_and_b32 v26, 31, v0
    v_lshrrev_b32 v27, 5, v0
    v_lshrrev_b32 v28, 1, v26
    v_and_b32 v28, 7, v28
    v_xor_b32 v28, v28, v27
    v_lshlrev_b32 v28, 4, v28
    s_mul_i32 s68, s77, 131072
    s_and_b32 s3, s52, 1
    s_lshl_b32 s3, s3, 12
    s_add_u32 s3, s3, s68
    v_lshlrev_b32 v29, 7, v26
    v_add_u32 v29, s3, v29
    v_add_u32 v10, v29, v28
    v_xor_b32 v11, 32, v10
    v_xor_b32 v12, 64, v10
    v_xor_b32 v13, 96, v10
    s_lshr_b32 s69, s76, 1
    v_lshrrev_b32 v28, 2, v0
    v_and_b32 v28, 3, v28
    v_lshlrev_b32 v29, 3, v27
    v_add_u32 v29, v29, v28
    v_lshlrev_b32 v29, 7, v29
    v_lshrrev_b32 v28, 1, v28
    v_xor_b32 v28, s69, v28
    v_lshlrev_b32 v28, 6, v28
    v_add_u32 v29, v29, v28
    v_and_b32 v28, 16, v0
    v_lshlrev_b32 v28, 1, v28
    v_add_u32 v29, v29, v28
    v_and_b32 v28, 3, v0
    v_lshlrev_b32 v28, 3, v28
    v_add_u32 v29, v29, v28
    v_add_u32 v14, s68, v29
    v_mov_b32 v32, 0
    v_mov_b32 v33, 0
    v_mov_b32 v34, 0
    v_mov_b32 v35, 0
    v_mov_b32 v36, 0
    v_mov_b32 v37, 0
    v_mov_b32 v38, 0
    v_mov_b32 v39, 0
    v_mov_b32 v40, 0
    v_mov_b32 v41, 0
    v_mov_b32 v42, 0
    v_mov_b32 v43, 0
    v_mov_b32 v44, 0
    v_mov_b32 v45, 0
    v_mov_b32 v46, 0
    v_mov_b32 v47, 0
    v_mov_b32 v48, 0
    v_mov_b32 v49, 0
    v_mov_b32 v50, 0
    v_mov_b32 v51, 0
    v_mov_b32 v52, 0
    v_mov_b32 v53, 0
    v_mov_b32 v54, 0
    v_mov_b32 v55, 0
    v_mov_b32 v56, 0
    v_mov_b32 v57, 0
    v_mov_b32 v58, 0
    v_mov_b32 v59, 0
    v_mov_b32 v60, 0
    v_mov_b32 v61, 0
    v_mov_b32 v62, 0
    v_mov_b32 v63, 0
    v_mov_b32 v64, 0
    v_mov_b32 v65, 0
    v_mov_b32 v66, 0
    v_mov_b32 v67, 0
    v_mov_b32 v68, 0
    v_mov_b32 v69, 0
    v_mov_b32 v70, 0
    v_mov_b32 v71, 0
    v_mov_b32 v72, 0
    v_mov_b32 v73, 0
    v_mov_b32 v74, 0
    v_mov_b32 v75, 0
    v_mov_b32 v76, 0
    v_mov_b32 v77, 0
    v_mov_b32 v78, 0
    v_mov_b32 v79, 0
    s_lshr_b32 s63, s54, 2
    s_min_u32 s63, s63, 6
    s_and_b32 s3, s54, 3
    s_lshl_b32 s62, s53, 2
    s_add_u32 s62, s62, s3
    s_lshl_b32 s58, s53, 1
    s_lshr_b32 s61, s54, 4
    s_add_u32 s58, s58, s61
    s_and_b32 s59, s54, 15
    s_mul_i32 s60, s58, 7
    s_lshr_b32 s60, s60, 1
    s_cmp_eq_u32 s61, 0
    s_cselect_b32 s66, 0x0fffffff, 0xfffffff0
    s_mov_b32 s67, s66
    v_lshlrev_b32 v2, 4, v0
    s_mov_b32 s74, 0x3e8b97f6
    v_mov_b32 v9, 0
    v_mov_b32 v16, 0
    v_mov_b32 v17, 0
    v_mov_b32 v18, 0
    v_mov_b32 v21, 0
    v_mul_u32_u24 v15, 6656, v27
    v_add_u32 v15, v15, v2
    s_lshr_b32 s55, s53, 1
    s_lshl_b32 s55, s55, 3
    s_and_b32 s3, s54, 7
    s_add_u32 s55, s55, s3
    s_xor_b32 s3, s53, s77
    s_and_b32 s3, s3, 1
    s_lshl_b32 s3, s3, 2
    s_lshr_b32 s56, s54, 3
    s_add_u32 s56, s56, s3
    s_cmp_lt_u32 s56, 7
    s_cselect_b32 s57, 1, 0
    s_cmp_eq_u32 s77, 0
    s_cselect_b32 s68, 7340032, 0
    s_lshl_b32 s73, s55, 1
    s_and_b32 s3, s76, 1
    s_add_u32 s73, s73, s3
    s_mul_i32 s72, s73, 28672
    s_cmp_eq_u32 s57, 0
    s_cselect_b32 s3, 1073741824, 0
    s_add_u32 s72, s72, s3
    s_add_u32 s72, s72, s68
    s_lshl_b32 s71, s56, 1
    s_lshr_b32 s3, s76, 1
    s_add_u32 s71, s71, s3
    s_lshl_b32 s3, s71, 6
    s_add_u32 s73, s73, s3
    s_lshl_b32 s69, s71, 11
    s_add_u32 s69, s69, s72
    s_add_u32 s70, s69, 1835008
    s_lshl_b32 s71, s71, 9
    s_add_u32 s71, s71, s72
    s_add_u32 s71, s71, 3670016
    s_add_u32 s72, s71, 14336
    s_waitcnt lgkmcnt(0)
    s_mov_b32 s24, s20
    s_and_b32 s25, s21, 0xffff
    s_mov_b32 s26, 0xe49000
    s_mov_b32 s27, 0x20000
    v_mov_b32 v4, 14974976
    buffer_load_dword v4, v4, s[24:27], 0 offen sc1
    s_mov_b32 s36, s16
    s_and_b32 s37, s17, 0xffff
    s_mov_b32 s38, 0x380000
    s_mov_b32 s39, 0x20000
    s_mov_b32 s40, s8
    s_and_b32 s41, s9, 0xffff
    s_mov_b32 s42, 0x62000
    s_mov_b32 s43, 0x20000
    s_mov_b32 s44, s14
    s_and_b32 s45, s15, 0xffff
    s_mov_b32 s46, 0x62000
    s_mov_b32 s47, 0x20000
    s_getpc_b64 s[18:19]
H_pc:
    s_add_u32 s18, s18, L_ones-H_pc
    s_addc_u32 s19, s19, 0
    s_mov_b32 s79, 32768
    s_cmp_eq_u32 s77, 0
    s_cbranch_scc1 C_bb
    s_lshl_b32 s3, s54, 2
    s_add_u32 s3, s3, s76
    s_lshl_b32 s3, s3, 7
    s_min_u32 s3, s3, L_ones-C_b0-64
    s_sub_u32 s22, s18, L_ones-C_b0
    s_subb_u32 s23, s19, 0
    s_load_dword s0, s[22:23], s3
    s_add_u32 s3, s3, 64
    s_load_dword s0, s[22:23], s3
    v_lshrrev_b32 v164, 3, v0
    v_and_b32 v165, 7, v0
    v_lshrrev_b32 v166, 4, v0
    s_lshl_b32 s3, s76, 4
    v_add_u32 v164, s3, v164
    v_mul_u32_u24 v7, 2688, v164
    v_mul_u32_u24 v164, 896, v164
    v_xor_b32 v5, v165, v166
    v_lshlrev_b32 v5, 4, v5
    v_add_u32 v5, v164, v5
    v_add_u32 v6, 7168, v5
    v_xor_b32 v6, 64, v6
    v_and_b32 v164, 1, v166
    v_lshlrev_b32 v164, 2, v164
    v_xor_b32 v164, v164, v165
    v_lshlrev_b32 v164, 4, v164
    v_add_u32 v7, v7, v164
    s_cmp_lg_u32 s57, 0
    s_cselect_b32 s22, 1835008, 0
    s_cselect_b32 s23, 1204224, 0
    s_mul_i32 s15, s55, 57344
    s_lshl_b32 s16, s56, 7
    s_xor_b32 s14, s55, s56
    s_and_b32 s14, s14, 1
    s_mul_i32 s14, s14, 3
    s_add_u32 s14, s14, s53
    s_cmp_ge_u32 s14, 7
    s_cselect_b32 s3, 7, 0
    s_sub_u32 s14, s14, s3
    s_mov_b32 s28, s4
    s_and_b32 s29, s5, 0xffff
    s_mov_b32 s30, s22
    s_mov_b32 s31, 0x20000
    s_mov_b32 s32, s6
    s_and_b32 s33, s7, 0xffff
    s_mov_b32 s34, s23
    s_mov_b32 s35, 0x20000
    s_lshl_b32 s17, s76, 11
    s_add_u32 s17, s17, 131072
    s_mov_b32 s79, 0
    s_and_b32 s3, s2, 193
    s_cmp_lg_u32 s3, 193
    s_cbranch_scc1 C_nipf
    s_lshl_b32 s3, s55, 2
    s_add_u32 s3, s3, s76
    s_mul_i32 s22, s3, 14336
    s_mul_i32 s23, s3, 9408
    s_and_b32 s23, s23, -128
    s_mov_b32 m0, s17
    s_waitcnt vmcnt(0)
    buffer_load_dwordx4 v2, s[28:31], s22 offen lds
    s_add_u32 s22, s22, 1024
    buffer_load_dwordx4 v2, s[32:35], s23 offen lds
    s_add_u32 s23, s23, 1024
    buffer_load_dwordx4 v2, s[28:31], s22 offen lds
    s_add_u32 s22, s22, 1024
    buffer_load_dwordx4 v2, s[32:35], s23 offen lds
    s_add_u32 s23, s23, 1024
    buffer_load_dwordx4 v2, s[28:31], s22 offen lds
    s_add_u32 s22, s22, 1024
    buffer_load_dwordx4 v2, s[32:35], s23 offen lds
    s_add_u32 s23, s23, 1024
    buffer_load_dwordx4 v2, s[28:31], s22 offen lds
    s_add_u32 s22, s22, 1024
    buffer_load_dwordx4 v2, s[32:35], s23 offen lds
    s_add_u32 s23, s23, 1024
    buffer_load_dwordx4 v2, s[28:31], s22 offen lds
    s_add_u32 s22, s22, 1024
    buffer_load_dwordx4 v2, s[32:35], s23 offen lds
    s_add_u32 s23, s23, 1024
    buffer_load_dwordx4 v2, s[28:31], s22 offen lds
    s_add_u32 s22, s22, 1024
    buffer_load_dwordx4 v2, s[32:35], s23 offen lds
    s_add_u32 s23, s23, 1024
    buffer_load_dwordx4 v2, s[28:31], s22 offen lds
    s_add_u32 s22, s22, 1024
    buffer_load_dwordx4 v2, s[32:35], s23 offen lds
    s_add_u32 s23, s23, 1024
    buffer_load_dwordx4 v2, s[28:31], s22 offen lds
    s_add_u32 s22, s22, 1024
    buffer_load_dwordx4 v2, s[32:35], s23 offen lds
    s_add_u32 s23, s23, 1024
    buffer_load_dwordx4 v2, s[28:31], s22 offen lds
    s_add_u32 s22, s22, 1024
    buffer_load_dwordx4 v2, s[32:35], s23 offen lds
    s_add_u32 s23, s23, 1024
    buffer_load_dwordx4 v2, s[28:31], s22 offen lds
    s_add_u32 s22, s22, 1024
    buffer_load_dwordx4 v2, s[32:35], s23 offen lds
    s_add_u32 s23, s23, 1024
    buffer_load_dwordx4 v2, s[28:31], s22 offen lds
    s_add_u32 s22, s22, 1024
    buffer_load_dwordx4 v2, s[28:31], s22 offen lds
    s_add_u32 s22, s22, 1024
    buffer_load_dwordx4 v2, s[28:31], s22 offen lds
    s_add_u32 s22, s22, 1024
    buffer_load_dwordx4 v2, s[28:31], s22 offen lds
    s_add_u32 s22, s22, 1024
C_nipf:
    s_lshl_b32 s11, s76, 12
    s_lshl_b32 s8, s60, 9
    s_lshl_b32 s9, s60, 7
    s_lshl_b32 s12, s59, 2
    s_add_u32 s12, s12, s76
    s_and_b32 s10, s59, 7
    s_add_u32 s10, s10, 1
    s_lshl_b32 s10, s10, 3
    s_lshl_b32 s3, s76, 1
    s_add_u32 s10, s10, s3
    s_and_b32 s10, s10, 63
    v_bfe_u32 v160, v0, 3, 1
    v_mul_u32_u24 v160, 3, v160
    v_add_u32 v160, s60, v160
    v_lshrrev_b32 v163, 2, v160
    v_lshlrev_b32 v163, 6, v163
    s_cmp_eq_u32 s12, 0
    s_cselect_b32 s3, 0, 1
    v_and_b32 v162, s3, v0
    v_sub_u32 v162, s12, v162
    v_add_u32 v162, v162, v163
    v_lshlrev_b32 v162, 7, v162
    v_add_u32 v17, 14712832, v162
    s_and_b32 s3, s2, 0xc1
    s_cmp_eq_u32 s3, 0xc1
    s_cbranch_scc1 C_sk0
    s_barrier
C_sk0:
    v_lshrrev_b32 v160, 3, v0
    s_lshl_b32 s3, s76, 3
    v_add_u32 v161, s3, v160
    v_mul_u32_u24 v161, 896, v161
    v_and_b32 v160, 2, v160
    s_and_b32 s3, s76, 1
    v_or_b32 v160, s3, v160
    v_lshlrev_b32 v160, 1, v160
    v_and_b32 v162, 7, v0
    v_xor_b32 v160, v160, v162
    v_lshlrev_b32 v160, 4, v160
    v_add_u32 v161, v161, v160
    s_lshl_b32 s3, s63, 7
    v_add_u32 v16, s3, v161
    v_lshlrev_b32 v18, 7, v162
    v_lshrrev_b32 v161, 2, v0
    v_and_b32 v161, 3, v161
    v_lshlrev_b32 v162, 3, v27
    v_add_u32 v162, v162, v161
    v_lshlrev_b32 v162, 7, v162
    v_and_b32 v161, 2, v161
    v_or_b32 v161, v161, v27
    v_bfe_u32 v163, v0, 4, 1
    v_xor_b32 v161, v161, v163
    v_lshlrev_b32 v161, 5, v161
    v_add_u32 v162, v162, v161
    v_and_b32 v161, 3, v0
    v_lshlrev_b32 v161, 3, v161
    v_add_u32 v162, v162, v161
    s_lshr_b32 s3, s76, 1
    s_mul_i32 s3, s3, 65536
    s_add_u32 s3, s3, 65536
    v_add_u32 v19, s3, v162
    v_xor_b32 v20, 64, v19
    v_mul_u32_u24 v21, 1792, v26
    v_lshlrev_b32 v160, 4, v27
    v_add_u32 v21, v21, v160
    s_add_u32 s3, s11, 114688
    v_add_u32 v22, s3, v2
    v_xor_b32 v23, 8192, v22
    s_and_b32 s3, s2, 0xc1
    s_cmp_eq_u32 s3, 0xc1
    s_cbranch_scc1 C_sk1
    s_barrier
C_sk1:
    v_lshlrev_b32 v161, 2, v27
    v_and_b32 v160, 30, v0
    v_sub_u32 v160, v160, v161
    v_add_u32 v160, 18, v160
    v_mov_b32 v162, 0x5555
    v_mov_b32 v163, 0
    v_lshlrev_b64 v[162:163], v160, v[162:163]
    s_cmp_eq_u32 s12, 0
    s_cselect_b32 s3, 0, -1
    v_and_b32 v162, s3, v162
    v_bfe_i32 v24, v0, 0, 1
    v_xor_b32 v25, 0xffff, v24
    s_mov_b32 s3, 0xf149f2ca
    v_bfe_i32 v144, v162, 16, 1
    v_bfe_i32 v145, v162, 18, 1
    v_bfe_i32 v146, v162, 24, 1
    v_bfe_i32 v147, v162, 26, 1
    v_bfe_i32 v148, v163, 0, 1
    v_bfe_i32 v149, v163, 2, 1
    v_bfe_i32 v150, v163, 8, 1
    v_bfe_i32 v151, v163, 10, 1
    v_bfe_i32 v152, v163, 16, 1
    v_bfe_i32 v153, v163, 18, 1
    v_bfe_i32 v154, v163, 24, 1
    v_bfe_i32 v155, v163, 26, 1
    v_bitop3_b32 v156, v144, v148, v152 bitop3:0x01
    v_and_b32 v156, s3, v156
    v_bitop3_b32 v157, v145, v149, v153 bitop3:0x01
    v_and_b32 v157, s3, v157
    v_bitop3_b32 v158, v146, v150, v154 bitop3:0x01
    v_and_b32 v158, s3, v158
    v_bitop3_b32 v159, v147, v151, v155 bitop3:0x01
    v_and_b32 v159, s3, v159
    s_and_b32 s3, s2, 0xc1
    s_cmp_eq_u32 s3, 0xc1
    s_cbranch_scc1 C_sk2
    s_barrier
C_sk2:
    s_and_b32 s3, s2, 0xc1
    s_cmp_eq_u32 s3, 0xc1
    s_cbranch_scc1 C_sk3
    s_barrier
C_sk3:
    s_and_b32 s3, s2, 0xc1
    s_cmp_eq_u32 s3, 0xc1
    s_cbranch_scc1 C_sk4
    s_barrier
C_sk4:
    s_lshl_b32 s22, s14, 7
    s_mov_b32 m0, s17
    s_add_u32 s22, s22, s15
    s_mul_i32 s23, s14, 172032
    buffer_load_dwordx4 v5, s[28:31], s22 offen lds
    s_add_u32 m0, s17, 1024
    s_add_u32 s23, s23, s16
    buffer_load_dwordx4 v6, s[28:31], s22 offen lds
    s_add_u32 m0, s17, 16384
    s_add_u32 s22, s23, 896
    buffer_load_dwordx4 v7, s[32:35], s22 offen lds
    s_add_u32 m0, s17, 17408
    s_add_u32 s22, s23, 22400
    buffer_load_dwordx4 v7, s[32:35], s22 offen lds
    s_add_u32 m0, s17, 24576
    s_add_u32 s22, s23, 1792
    buffer_load_dwordx4 v7, s[32:35], s22 offen lds
    s_add_u32 m0, s17, 25600
    s_add_u32 s22, s23, 23296
    buffer_load_dwordx4 v7, s[32:35], s22 offen lds
    s_add_u32 m0, s17, 8192
    s_add_u32 s22, s23, 0
    buffer_load_dwordx4 v7, s[32:35], s22 offen lds
    s_add_u32 m0, s17, 9216
    s_add_u32 s22, s23, 21504
    buffer_load_dwordx4 v7, s[32:35], s22 offen lds
    s_barrier
    s_waitcnt vmcnt(0) lgkmcnt(0)
    v_readfirstlane_b32 s64, v4
    s_nop 3
    s_mul_i32 s64, s64, 0x9e3779b1
    s_add_u32 s64, s64, 0x7f4a7c15
    s_not_b32 s65, s64
C_b0:
    s_mov_b32 s75, 7
C_w:
    s_barrier
    ds_read_b128 v[80:83], v10
    ds_read_b64_tr_b16 v[88:89], v14 offset:16384
    ds_read_b64_tr_b16 v[90:91], v14 offset:16896
    ds_read_b64_tr_b16 v[92:93], v14 offset:24576
    ds_read_b64_tr_b16 v[94:95], v14 offset:25088
    ds_read_b64_tr_b16 v[84:85], v14 offset:8192
    ds_read_b64_tr_b16 v[86:87], v14 offset:8704
    ds_read_b128 v[96:99], v11
    ds_read_b64_tr_b16 v[104:105], v14 offset:18432
    ds_read_b64_tr_b16 v[106:107], v14 offset:18944
    ds_read_b64_tr_b16 v[108:109], v14 offset:26624
    ds_read_b64_tr_b16 v[110:111], v14 offset:27136
    ds_read_b64_tr_b16 v[100:101], v14 offset:10240
    ds_read_b64_tr_b16 v[102:103], v14 offset:10752
C_g:
    s_waitcnt lgkmcnt(7)
    v_mfma_f32_32x32x16_bf16 v[48:63], v[88:91], v[80:83], v[48:63]
    ds_read_b128 v[112:115], v12
    ds_read_b64_tr_b16 v[120:121], v14 offset:20480
    ds_read_b64_tr_b16 v[122:123], v14 offset:20992
    v_mfma_f32_32x32x16_bf16 v[64:79], v[80:83], v[92:95], v[64:79]
    ds_read_b64_tr_b16 v[124:125], v14 offset:28672
    ds_read_b64_tr_b16 v[126:127], v14 offset:29184
    v_mfma_f32_32x32x16_bf16 v[32:47], v[84:87], v[80:83], v[32:47]
    ds_read_b64_tr_b16 v[116:117], v14 offset:12288
    ds_read_b64_tr_b16 v[118:119], v14 offset:12800
    s_waitcnt lgkmcnt(7)
    v_mfma_f32_32x32x16_bf16 v[48:63], v[104:107], v[96:99], v[48:63]
    ds_read_b128 v[128:131], v13
    ds_read_b64_tr_b16 v[136:137], v14 offset:22528
    ds_read_b64_tr_b16 v[138:139], v14 offset:23040
    v_mfma_f32_32x32x16_bf16 v[64:79], v[96:99], v[108:111], v[64:79]
    ds_read_b64_tr_b16 v[140:141], v14 offset:30720
    ds_read_b64_tr_b16 v[142:143], v14 offset:31232
    v_mfma_f32_32x32x16_bf16 v[32:47], v[100:103], v[96:99], v[32:47]
    ds_read_b64_tr_b16 v[132:133], v14 offset:14336
    ds_read_b64_tr_b16 v[134:135], v14 offset:14848
    v_add_u32 v10, s79, v10
    v_and_b32 v10, 131071, v10
    v_add_u32 v11, s79, v11
    v_and_b32 v11, 131071, v11
    v_add_u32 v12, s79, v12
    v_and_b32 v12, 131071, v12
    v_add_u32 v13, s79, v13
    v_and_b32 v13, 131071, v13
    v_add_u32 v14, s79, v14
    v_and_b32 v14, 131071, v14
    s_mov_b32 s79, 32768
    s_sub_u32 s75, s75, 1
    s_cmp_le_u32 s75, 1
    s_cbranch_scc1 C_gx
    s_waitcnt lgkmcnt(0)
    s_barrier
    v_mfma_f32_32x32x16_bf16 v[48:63], v[120:123], v[112:115], v[48:63]
    ds_read_b128 v[80:83], v10
    ds_read_b64_tr_b16 v[88:89], v14 offset:16384
    ds_read_b64_tr_b16 v[90:91], v14 offset:16896
    v_mfma_f32_32x32x16_bf16 v[64:79], v[112:115], v[124:127], v[64:79]
    ds_read_b64_tr_b16 v[92:93], v14 offset:24576
    ds_read_b64_tr_b16 v[94:95], v14 offset:25088
    v_mfma_f32_32x32x16_bf16 v[32:47], v[116:119], v[112:115], v[32:47]
    ds_read_b64_tr_b16 v[84:85], v14 offset:8192
    ds_read_b64_tr_b16 v[86:87], v14 offset:8704
    v_mfma_f32_32x32x16_bf16 v[48:63], v[136:139], v[128:131], v[48:63]
    ds_read_b128 v[96:99], v11
    ds_read_b64_tr_b16 v[104:105], v14 offset:18432
    ds_read_b64_tr_b16 v[106:107], v14 offset:18944
    v_mfma_f32_32x32x16_bf16 v[64:79], v[128:131], v[140:143], v[64:79]
    ds_read_b64_tr_b16 v[108:109], v14 offset:26624
    ds_read_b64_tr_b16 v[110:111], v14 offset:27136
    v_mfma_f32_32x32x16_bf16 v[32:47], v[132:135], v[128:131], v[32:47]
    ds_read_b64_tr_b16 v[100:101], v14 offset:10240
    ds_read_b64_tr_b16 v[102:103], v14 offset:10752
    s_branch C_g
C_gx:
    s_waitcnt lgkmcnt(7)
    v_mfma_f32_32x32x16_bf16 v[48:63], v[120:123], v[112:115], v[48:63]
    v_mfma_f32_32x32x16_bf16 v[64:79], v[112:115], v[124:127], v[64:79]
    v_mfma_f32_32x32x16_bf16 v[32:47], v[116:119], v[112:115], v[32:47]
    s_waitcnt lgkmcnt(0)
    v_mfma_f32_32x32x16_bf16 v[48:63], v[136:139], v[128:131], v[48:63]
    v_mfma_f32_32x32x16_bf16 v[64:79], v[128:131], v[140:143], v[64:79]
    v_mfma_f32_32x32x16_bf16 v[32:47], v[132:135], v[128:131], v[32:47]
    s_cmp_eq_u32 s75, 1
    s_cbranch_scc1 C_w
    s_nop 8
    v_cvt_pk_bf16_f32 v88, v48, v49
    v_cvt_pk_bf16_f32 v89, v50, v51
    v_cvt_pk_bf16_f32 v90, v52, v53
    v_cvt_pk_bf16_f32 v91, v54, v55
    v_cvt_pk_bf16_f32 v92, v56, v57
    v_cvt_pk_bf16_f32 v93, v58, v59
    v_cvt_pk_bf16_f32 v94, v60, v61
    v_cvt_pk_bf16_f32 v95, v62, v63
    v_cvt_pk_bf16_f32 v96, v64, v65
    v_cvt_pk_bf16_f32 v97, v66, v67
    v_cvt_pk_bf16_f32 v98, v68, v69
    v_cvt_pk_bf16_f32 v99, v70, v71
    v_cvt_pk_bf16_f32 v100, v72, v73
    v_cvt_pk_bf16_f32 v101, v74, v75
    v_cvt_pk_bf16_f32 v102, v76, v77
    v_cvt_pk_bf16_f32 v103, v78, v79
    v_permlane32_swap_b32 v88, v90
    v_permlane32_swap_b32 v89, v91
    v_permlane32_swap_b32 v92, v94
    v_permlane32_swap_b32 v93, v95
    s_cmp_lg_u32 s77, 0
    s_cbranch_scc1 C_ns
    buffer_store_dwordx4 v[96:99], v15, s[24:27], s71 offen sc1
    buffer_store_dwordx4 v[100:103], v15, s[24:27], s72 offen sc1
    buffer_store_dwordx4 v[88:91], v2, s[24:27], s70 offen sc1
    buffer_store_dwordx4 v[92:95], v2, s[24:27], s70 offen offset:1024 sc1
C_ns:
    v_mul_f32 v32, s74, v32
    v_mul_f32 v33, s74, v33
    v_mul_f32 v34, s74, v34
    v_mul_f32 v35, s74, v35
    v_mul_f32 v36, s74, v36
    v_mul_f32 v37, s74, v37
    v_mul_f32 v38, s74, v38
    v_mul_f32 v39, s74, v39
    v_mul_f32 v40, s74, v40
    v_mul_f32 v41, s74, v41
    v_mul_f32 v42, s74, v42
    v_mul_f32 v43, s74, v43
    v_mul_f32 v44, s74, v44
    v_mul_f32 v45, s74, v45
    v_mul_f32 v46, s74, v46
    v_mul_f32 v47, s74, v47
    v_cvt_pk_bf16_f32 v80, v32, v33
    v_cvt_pk_bf16_f32 v81, v34, v35
    v_cvt_pk_bf16_f32 v82, v36, v37
    v_cvt_pk_bf16_f32 v83, v38, v39
    v_cvt_pk_bf16_f32 v84, v40, v41
    v_cvt_pk_bf16_f32 v85, v42, v43
    v_cvt_pk_bf16_f32 v86, v44, v45
    v_cvt_pk_bf16_f32 v87, v46, v47
    s_nop 1
    v_permlane32_swap_b32 v80, v82
    v_permlane32_swap_b32 v81, v83
    v_permlane32_swap_b32 v84, v86
    v_permlane32_swap_b32 v85, v87
    s_cbranch_scc1 L_helper
    buffer_store_dwordx4 v[80:83], v2, s[24:27], s69 offen sc1
    buffer_store_dwordx4 v[84:87], v2, s[24:27], s69 offen offset:1024 sc1
C_pub:
    s_barrier
    s_lshl_b32 s3, s56, 5
    s_add_u32 s3, s3, s55
    s_lshl_b32 s3, s3, 7
    s_add_u32 s13, s3, 14680064
    s_lshl_b32 s11, s76, 12
    s_lshl_b32 s8, s60, 9
    s_lshl_b32 s9, s60, 7
    s_lshl_b32 s12, s59, 2
    s_add_u32 s12, s12, s76
    s_and_b32 s10, s59, 7
    s_add_u32 s10, s10, 0
    s_lshl_b32 s10, s10, 3
    s_lshl_b32 s3, s76, 1
    s_add_u32 s10, s10, s3
    s_and_b32 s10, s10, 63
    v_bfe_u32 v28, v0, 3, 1
    v_mul_u32_u24 v28, 3, v28
    v_add_u32 v28, s60, v28
    v_lshrrev_b32 v31, 3, v28
    v_lshlrev_b32 v31, 5, v31
    s_lshr_b32 s3, s12, 1
    v_mov_b32 v29, s3
    s_mov_b64 exec, 0xffff
    v_and_b32 v29, 7, v0
    v_lshlrev_b32 v29, 2, v29
    v_add_u32 v29, s76, v29
    s_mov_b64 exec, -1
    v_add_u32 v29, v29, v31
    v_lshlrev_b32 v29, 7, v29
    v_add_u32 v32, 14680064, v29
    s_and_b32 s51, s63, 1
    s_xor_b32 s51, s51, 0
    s_add_u32 s78, s76, 0
    s_lshl_b32 s3, s59, 2
    s_add_u32 s3, s3, s76
    s_mul_i32 s3, s3, 28672
    s_lshl_b32 s50, s60, 9
    s_add_u32 s50, s50, s3
    s_add_u32 s50, s50, 12845056
    v_add_u32 v148, 131072, v2
    v_add_u32 v149, 98304, v2
    v_add_u32 v150, 0, v2
    v_add_u32 v152, 139264, v2
    s_lshl_b32 s3, s76, 11
    s_add_u32 s3, s3, 65536
    v_add_u32 v151, s3, v2
    s_lshl_b32 s3, s76, 10
    v_add_u32 v160, s3, v2
    v_add_u32 v153, 57344, v160
    v_add_u32 v156, 61440, v160
    v_add_u32 v154, 98304, v160
    v_add_u32 v157, 106496, v160
    v_lshrrev_b32 v160, 2, v160
    v_add_u32 v155, 102400, v160
    v_add_u32 v158, 110592, v160
    v_lshrrev_b32 v160, 4, v0
    v_lshrrev_b32 v161, 2, v0
    v_and_b32 v161, 3, v161
    v_lshlrev_b32 v162, 3, v160
    v_add_u32 v162, v162, v161
    v_lshlrev_b32 v162, 7, v162
    v_and_b32 v161, 2, v161
    v_and_b32 v163, 1, v160
    v_or_b32 v161, v161, v163
    v_lshlrev_b32 v161, 5, v161
    v_add_u32 v162, v162, v161
    v_and_b32 v161, 3, v0
    v_lshlrev_b32 v161, 3, v161
    v_add_u32 v162, v162, v161
    s_mul_i32 s3, s51, 28672
    v_add_u32 v164, s3, v162
    s_lshl_b32 s3, s51, 6
    v_xor_b32 v164, s3, v164
    v_xor_b32 v165, 32, v164
    v_xor_b32 v166, 64, v164
    v_xor_b32 v167, 96, v164
    s_lshl_b32 s49, s62, 1
    s_lshr_b32 s3, s76, 1
    s_add_u32 s49, s49, s3
    s_mul_i32 s49, s49, 28672
    s_and_b32 s3, s76, 1
    s_lshl_b32 s3, s3, 8
    s_add_u32 s49, s49, s3
    s_mul_i32 s3, s51, 14336
    s_add_u32 s49, s49, s3
    s_add_u32 s49, s49, 12845056
    v_and_b32 v161, 15, v0
    v_lshlrev_b32 v162, 9, v160
    v_lshlrev_b32 v159, 4, v161
    v_add_u32 v162, v162, v159
    s_lshl_b32 s3, s62, 2
    s_add_u32 s3, s3, s76
    s_lshl_b32 s3, s3, 4
    v_add_u32 v161, s3, v161
    v_mul_u32_u24 v161, 1792, v161
    v_lshlrev_b32 v163, 5, v163
    v_add_u32 v161, v161, v163
    v_lshrrev_b32 v163, 1, v160
    v_lshlrev_b32 v163, 4, v163
    v_add_u32 v161, v161, v163
    s_lshl_b32 s48, s63, 7
    s_lshl_b32 s3, s51, 6
    s_add_u32 s48, s48, s3
    s_add_u32 s48, s48, 896
    v_mov_b32 v104, 0
    v_mov_b32 v105, 0
    v_mov_b32 v106, 0
    v_mov_b32 v107, 0
    v_mov_b32 v108, 0
    v_mov_b32 v109, 0
    v_mov_b32 v110, 0
    v_mov_b32 v111, 0
    v_mov_b32 v112, 0
    v_mov_b32 v113, 0
    v_mov_b32 v114, 0
    v_mov_b32 v115, 0
    v_mov_b32 v116, 0
    v_mov_b32 v117, 0
    v_mov_b32 v118, 0
    v_mov_b32 v119, 0
    v_mov_b32 v64, 0
    v_mov_b32 v65, 0
    v_mov_b32 v66, 0
    v_mov_b32 v67, 0
    v_mov_b32 v132, 0
    v_mov_b32 v133, 0
    v_mov_b32 v134, 0
    v_mov_b32 v135, 0
    s_waitcnt vmcnt(0)
    v_readfirstlane_b32 s64, v4
    s_nop 3
    s_mul_i32 s64, s64, 0x9e3779b1
    s_add_u32 s64, s64, 0x7f4a7c15
    s_not_b32 s65, s64
    s_barrier
    s_cmp_lg_u32 s52, 0
    s_cbranch_scc1 H_nofl
    v_mov_b32 v28, s64
    v_mov_b32 v29, s65
    s_mov_b64 exec, 1
    buffer_store_dwordx2 v[28:29], v2, s[24:27], s13 offen sc1
    s_mov_b64 exec, -1
H_nofl:
    s_not_b64 exec, s[66:67]
    s_add_u32 m0, s11, 147456
    s_nop 0
    global_load_lds_dwordx4 v9, s[18:19]
    s_add_u32 m0, s11, 148480
    s_nop 0
    global_load_lds_dwordx4 v9, s[18:19]
    s_add_u32 m0, s11, 149504
    s_nop 0
    global_load_lds_dwordx4 v9, s[18:19]
    s_add_u32 m0, s11, 150528
    s_nop 0
    global_load_lds_dwordx4 v9, s[18:19]
    s_mov_b64 exec, -1
    s_barrier
    s_barrier
    buffer_load_dwordx2 v[30:31], v32, s[24:27], 0 offen sc1
    s_barrier
    s_mov_b32 s13, 1
    s_waitcnt vmcnt(0)
    v_cmp_ne_u64 vcc, s[64:65], v[30:31]
    s_cmp_eq_u64 vcc, 0
    s_cbranch_scc1 H_ok
    buffer_load_dwordx2 v[30:31], v32, s[24:27], 0 offen sc1
    s_barrier
    s_mov_b32 s13, 0
    s_waitcnt vmcnt(0)
    v_cmp_ne_u64 vcc, s[64:65], v[30:31]
    s_cmp_eq_u64 vcc, 0
    s_cbranch_scc1 H_ok
    s_cmp_lg_u32 s57, 0
    s_cbranch_scc1 H_np
    s_mov_b64 exec, 1
    s_mov_b32 s79, 262144
poll_1:
    buffer_load_dwordx2 v[30:31], v32, s[24:27], 0 offen sc1
    s_waitcnt vmcnt(0)
    v_cmp_ne_u64 vcc, s[64:65], v[30:31]
    s_sub_u32 s79, s79, 1
    s_cbranch_scc1 poll_1_x
    s_cmp_eq_u64 vcc, 0
    s_cbranch_scc1 poll_1_x
    s_mov_b64 exec, vcc
    s_sleep 4
    s_branch poll_1
poll_1_x:
    s_mov_b64 exec, -1
H_np:
    s_mov_b32 s79, 262144
poll_2:
    buffer_load_dwordx2 v[30:31], v32, s[24:27], 0 offen sc1
    s_waitcnt vmcnt(0)
    v_cmp_ne_u64 vcc, s[64:65], v[30:31]
    s_sub_u32 s79, s79, 1
    s_cbranch_scc1 poll_2_x
    s_cmp_eq_u64 vcc, 0
    s_cbranch_scc1 poll_2_x
    s_mov_b64 exec, vcc
    s_sleep 1
    s_branch poll_2
poll_2_x:
    s_mov_b64 exec, -1
H_ok:
    s_lshr_b32 s3, s11, 1
    s_add_u32 m0, s3, 65536
    s_sub_u32 s3, s50, 5505024
    buffer_load_dwordx4 v2, s[24:27], s3 offen sc1 lds
    buffer_load_dwordx4 v2, s[24:27], s3 offen offset:1024 sc1 lds
    s_mul_i32 s68, s10, 28672
    s_add_u32 m0, s11, 131072
    s_add_u32 s22, s68, s8
    s_add_u32 s22, s22, 9175040
    buffer_load_dwordx4 v2, s[24:27], s22 offen sc1 lds
    s_add_u32 s23, s22, 26624
    buffer_load_dwordx4 v2, s[24:27], s22 offen offset:1024 sc1 lds
    s_add_u32 s68, s68, s9
    buffer_load_dwordx4 v2, s[24:27], s23 offen offset:2048 sc1 lds
    s_add_u32 s68, s68, 11010048
    buffer_load_dwordx4 v2, s[24:27], s23 offen offset:3072 sc1 lds
    s_add_u32 m0, s11, 147456
    s_mov_b64 exec, s[66:67]
    buffer_load_dwordx4 v15, s[24:27], s68 offen offset:0 sc1 lds
    s_add_u32 s68, s68, 13312
    buffer_load_dwordx4 v15, s[24:27], s68 offen offset:1024 sc1 lds
    s_add_u32 s68, s68, 13312
    buffer_load_dwordx4 v15, s[24:27], s68 offen offset:2048 sc1 lds
    s_add_u32 s68, s68, 13312
    buffer_load_dwordx4 v15, s[24:27], s68 offen offset:3072 sc1 lds
    s_mov_b64 exec, -1
    s_add_u32 s10, s10, 8
    s_and_b32 s10, s10, 63
H_rb:
    s_sub_u32 s13, s13, 1
    s_cbranch_scc1 H_b13
    s_barrier
    s_branch H_rb
H_b13:
    s_waitcnt vmcnt(0)
C_attn:
    s_setprio 1
    s_barrier
    ds_read_b128 v[4:7], v151
    ds_read_b128 v[8:11], v151 offset:1024
    ds_read_b128 v[12:15], v152
    ds_read_b128 v[16:19], v152 offset:1024
    ds_read_b128 v[20:23], v148
    ds_read_b128 v[24:27], v148 offset:1024
    ds_read_b128 v[120:123], v148 offset:2048
    ds_read_b128 v[124:127], v148 offset:3072
    ds_read_b128 v[128:131], v148 offset:16384
    s_waitcnt lgkmcnt(7)
    s_cmp_eq_u32 s61, 0
    s_cbranch_scc1 zf_3_e
    s_mov_b32 exec_hi, 0
    v_mov_b32 v4, 0
    v_mov_b32 v5, 0
    s_branch zf_3_x
zf_3_e:
    s_mov_b32 exec_lo, 0
    v_mov_b32 v10, 0
    v_mov_b32 v11, 0
zf_3_x:
    s_mov_b64 exec, -1
    s_waitcnt lgkmcnt(5)
    v_mfma_f32_32x32x16_bf16 v[44:59], v[12:15], v[4:7], 0
    v_mfma_f32_32x32x16_bf16 v[44:59], v[16:19], v[8:11], v[44:59]
    s_waitcnt lgkmcnt(3)
    v_mfma_f32_32x32x16_bf16 v[28:43], v[20:23], v[4:7], 0
    v_mfma_f32_32x32x16_bf16 v[28:43], v[24:27], v[8:11], v[28:43]
    s_mov_b32 s75, 0
    s_mov_b32 s72, 131072
    s_mov_b32 s73, 32768
    s_mov_b32 s74, 98304
    s_mov_b32 s3, 0xc2c00000
    s_nop 4
    v_max3_f32 v140, v44, v45, v46
    v_max3_f32 v141, v47, v48, v49
    v_max3_f32 v140, v140, v50, v51
    v_max3_f32 v141, v141, v52, v53
    v_max3_f32 v140, v140, v54, v55
    v_max3_f32 v141, v141, v56, v57
    v_max3_f32 v140, v140, v28, v29
    v_max3_f32 v141, v141, v30, v31
    v_max3_f32 v140, v140, v32, v33
    v_max3_f32 v141, v141, v34, v35
    v_max3_f32 v140, v140, v36, v37
    v_max3_f32 v141, v141, v38, v39
    v_max3_f32 v140, v140, v40, v41
    v_max3_f32 v141, v141, v42, v43
    v_max3_f32 v140, v140, v58, v59
    v_max_f32 v140, v140, v141
    v_mov_b32 v141, v140
    v_mov_b32 v58, 0
    v_mov_b32 v59, 0
    v_permlane32_swap_b32 v140, v141
    s_nop 1
    v_max_f32 v140, v140, v141
    v_sub_f32 v12, s3, v140
    v_add_f32 v28, v28, v12
    v_add_f32 v29, v29, v12
    v_add_f32 v30, v30, v12
    v_add_f32 v31, v31, v12
    v_add_f32 v32, v32, v12
    v_add_f32 v33, v33, v12
    v_add_f32 v34, v34, v12
    v_add_f32 v35, v35, v12
    v_add_f32 v36, v36, v12
    v_add_f32 v37, v37, v12
    v_add_f32 v38, v38, v12
    v_add_f32 v39, v39, v12
    v_add_f32 v40, v40, v12
    v_add_f32 v41, v41, v12
    v_add_f32 v42, v42, v12
    v_add_f32 v43, v43, v12
    v_mov_b32 v13, v12
    v_mov_b32 v14, v12
    v_mov_b32 v15, v12
    v_mov_b32 v16, v12
    v_mov_b32 v17, v12
    v_mov_b32 v18, v12
    v_mov_b32 v19, v12
    v_mov_b32 v20, v12
    v_mov_b32 v21, v12
    v_mov_b32 v22, v12
    v_mov_b32 v23, v12
    v_mov_b32 v24, v12
    v_mov_b32 v25, v12
    v_mov_b32 v26, v12
    v_mov_b32 v27, v12
    s_waitcnt lgkmcnt(0)
    s_setprio 1
    .p2align 3
C_loop:
    v_exp_f32 v28, v28
    v_exp_f32 v29, v29
    v_cvt_pk_bf16_f32 v67, v58, v59
    v_exp_f32 v30, v30
    s_waitcnt lgkmcnt(2)
    v_mfma_f32_32x32x16_bf16 v[44:59], v[120:123], v[4:7], v[12:27]
    ds_read_b128 v[120:123], v148 offset:4096
    v_cvt_pk_bf16_f32 v60, v28, v29
    v_exp_f32 v31, v31
    v_exp_f32 v32, v32
    v_cvt_pk_bf16_f32 v61, v30, v31
    v_exp_f32 v33, v33
    v_exp_f32 v34, v34
    v_mfma_f32_32x32x16_bf16 v[104:119], v[132:135], v[64:67], v[104:119]
    ds_read_b128 v[132:135], v148 offset:17408
    v_cvt_pk_bf16_f32 v62, v32, v33
    v_exp_f32 v35, v35
    v_exp_f32 v36, v36
    v_cvt_pk_bf16_f32 v63, v34, v35
    v_exp_f32 v37, v37
    s_waitcnt lgkmcnt(2)
    v_mfma_f32_32x32x16_bf16 v[44:59], v[124:127], v[8:11], v[44:59]
    ds_read_b128 v[124:127], v148 offset:5120
    v_exp_f32 v38, v38
    v_exp_f32 v39, v39
    v_cvt_pk_bf16_f32 v64, v36, v37
    v_exp_f32 v40, v40
    v_exp_f32 v41, v41
    v_cvt_pk_bf16_f32 v65, v38, v39
    v_mfma_f32_32x32x16_bf16 v[104:119], v[128:131], v[60:63], v[104:119]
    ds_read_b128 v[128:131], v148 offset:18432
    v_exp_f32 v42, v42
    v_exp_f32 v43, v43
    v_cvt_pk_bf16_f32 v66, v40, v41
    s_setprio 0
    s_add_u32 s75, s75, 1
    v_exp_f32 v44, v44
    v_exp_f32 v45, v45
    v_cvt_pk_bf16_f32 v67, v42, v43
    v_exp_f32 v46, v46
    s_waitcnt lgkmcnt(2)
    v_mfma_f32_32x32x16_bf16 v[28:43], v[120:123], v[4:7], v[12:27]
    ds_read_b128 v[120:123], v148 offset:6144
    v_cvt_pk_bf16_f32 v60, v44, v45
    v_exp_f32 v47, v47
    v_exp_f32 v48, v48
    v_cvt_pk_bf16_f32 v61, v46, v47
    v_exp_f32 v49, v49
    v_exp_f32 v50, v50
    v_mfma_f32_32x32x16_bf16 v[104:119], v[132:135], v[64:67], v[104:119]
    ds_read_b128 v[132:135], v148 offset:19456
    v_cvt_pk_bf16_f32 v62, v48, v49
    v_exp_f32 v51, v51
    v_exp_f32 v52, v52
    v_cvt_pk_bf16_f32 v63, v50, v51
    v_exp_f32 v53, v53
    s_waitcnt lgkmcnt(2)
    v_mfma_f32_32x32x16_bf16 v[28:43], v[124:127], v[8:11], v[28:43]
    ds_read_b128 v[124:127], v148 offset:7168
    v_exp_f32 v54, v54
    v_exp_f32 v55, v55
    v_cvt_pk_bf16_f32 v64, v52, v53
    v_exp_f32 v56, v56
    v_exp_f32 v57, v57
    v_cvt_pk_bf16_f32 v65, v54, v55
    v_mfma_f32_32x32x16_bf16 v[104:119], v[128:131], v[60:63], v[104:119]
    ds_read_b128 v[128:131], v148 offset:20480
    v_exp_f32 v58, v58
    v_exp_f32 v59, v59
    v_cvt_pk_bf16_f32 v66, v56, v57
    s_sub_u32 s74, s74, s73
    s_cmp_eq_u32 s74, s73
    v_exp_f32 v28, v28
    v_exp_f32 v29, v29
    v_cvt_pk_bf16_f32 v67, v58, v59
    v_exp_f32 v30, v30
    s_barrier
    s_setprio 3
    s_waitcnt lgkmcnt(2)
    v_mfma_f32_32x32x16_bf16 v[44:59], v[120:123], v[4:7], v[12:27]
    ds_read_b128 v[120:123], v149 offset:0
    v_cvt_pk_bf16_f32 v60, v28, v29
    v_exp_f32 v31, v31
    v_exp_f32 v32, v32
    v_cvt_pk_bf16_f32 v61, v30, v31
    v_exp_f32 v33, v33
    v_exp_f32 v34, v34
    v_mfma_f32_32x32x16_bf16 v[104:119], v[132:135], v[64:67], v[104:119]
    ds_read_b128 v[132:135], v148 offset:21504
    v_cvt_pk_bf16_f32 v62, v32, v33
    v_exp_f32 v35, v35
    v_exp_f32 v36, v36
    v_cvt_pk_bf16_f32 v63, v34, v35
    v_exp_f32 v37, v37
    s_waitcnt lgkmcnt(2)
    v_mfma_f32_32x32x16_bf16 v[44:59], v[124:127], v[8:11], v[44:59]
    ds_read_b128 v[124:127], v149 offset:1024
    v_exp_f32 v38, v38
    v_exp_f32 v39, v39
    v_cvt_pk_bf16_f32 v64, v36, v37
    v_exp_f32 v40, v40
    v_exp_f32 v41, v41
    v_cvt_pk_bf16_f32 v65, v38, v39
    v_mfma_f32_32x32x16_bf16 v[104:119], v[128:131], v[60:63], v[104:119]
    ds_read_b128 v[128:131], v148 offset:22528
    v_exp_f32 v42, v42
    v_exp_f32 v43, v43
    v_cvt_pk_bf16_f32 v66, v40, v41
    s_setprio 2
    s_cselect_b32 s74, s72, s74
    v_exp_f32 v44, v44
    v_exp_f32 v45, v45
    v_cvt_pk_bf16_f32 v67, v42, v43
    v_exp_f32 v46, v46
    s_waitcnt lgkmcnt(2)
    v_mfma_f32_32x32x16_bf16 v[28:43], v[120:123], v[4:7], v[12:27]
    ds_read_b128 v[120:123], v149 offset:2048
    v_cvt_pk_bf16_f32 v60, v44, v45
    v_exp_f32 v47, v47
    v_exp_f32 v48, v48
    v_cvt_pk_bf16_f32 v61, v46, v47
    v_exp_f32 v49, v49
    v_exp_f32 v50, v50
    v_mfma_f32_32x32x16_bf16 v[104:119], v[132:135], v[64:67], v[104:119]
    ds_read_b128 v[132:135], v148 offset:23552
    v_cvt_pk_bf16_f32 v62, v48, v49
    v_exp_f32 v51, v51
    v_exp_f32 v52, v52
    v_cvt_pk_bf16_f32 v63, v50, v51
    v_exp_f32 v53, v53
    s_waitcnt lgkmcnt(2)
    v_mfma_f32_32x32x16_bf16 v[28:43], v[124:127], v[8:11], v[28:43]
    ds_read_b128 v[124:127], v149 offset:3072
    v_exp_f32 v54, v54
    v_exp_f32 v55, v55
    v_cvt_pk_bf16_f32 v64, v52, v53
    v_exp_f32 v56, v56
    v_exp_f32 v57, v57
    v_cvt_pk_bf16_f32 v65, v54, v55
    v_mfma_f32_32x32x16_bf16 v[104:119], v[128:131], v[60:63], v[104:119]
    ds_read_b128 v[128:131], v149 offset:16384
    v_exp_f32 v58, v58
    v_exp_f32 v59, v59
    v_cvt_pk_bf16_f32 v66, v56, v57
    v_mov_b32 v148, v149
    s_setprio 1
    v_add_u32 v149, s74, v150
    s_cmp_lt_u32 s75, 8
    s_cbranch_scc1 C_loop
    v_cvt_pk_bf16_f32 v67, v58, v59
    s_waitcnt lgkmcnt(2)
    s_cmp_lg_u32 s77, 0
    v_mfma_f32_32x32x16_bf16 v[104:119], v[132:135], v[64:67], v[104:119]
    s_setprio 3
    s_cbranch_scc1 C_k1
    s_cmp_lg_u32 s61, 0
    s_cselect_b64 s[28:29], -1, 0
    s_cmp_lg_u32 s61, 0
    s_cselect_b32 s30, 0, -1
    s_cselect_b32 s31, -1, -1
    s_mov_b32 s3, 0xd800000
    v_mov_b32 v141, 0x207
    s_nop 2
    ds_write_b128 v153, v[112:115]
    v_mov_b32 v142, v116
    ds_write_b128 v154, v[116:119]
    s_mov_b64 exec, s[28:29]
    v_mov_b32 v142, v104
    s_mov_b64 exec, -1
    ds_write_b32 v155, v142
    s_waitcnt lgkmcnt(0)
    s_barrier
    ds_read_b32 v36, v158
    ds_read_b128 v[28:31], v156
    ds_read_b128 v[32:35], v157
    s_waitcnt lgkmcnt(2)
    v_add_f32 v142, v142, v36
    v_mov_b32 v143, v142
    s_nop 1
    v_permlane32_swap_b32 v143, v142
    s_mov_b64 exec, s[28:29]
    v_mov_b32 v142, v143
    s_mov_b64 exec, -1
    v_rcp_f32 v143, v142
    v_mul_f32 v140, 0, v142
    s_waitcnt lgkmcnt(0)
    v_add_f32 v104, v104, v28
    v_add_f32 v105, v105, v29
    v_add_f32 v106, v106, v30
    v_add_f32 v107, v107, v31
    v_add_f32 v108, v108, v32
    v_add_f32 v109, v109, v33
    v_add_f32 v110, v110, v34
    v_add_f32 v111, v111, v35
    v_add_f32 v28, abs(v104), abs(v105)
    v_add_f32 v29, abs(v106), abs(v107)
    v_add_f32 v30, abs(v108), abs(v109)
    v_add_f32 v31, abs(v110), abs(v111)
    v_add_f32 v28, v28, v29
    v_add_f32 v30, v30, v31
    v_add_f32 v140, v140, v28
    v_mul_f32 v104, v143, v104
    v_add_f32 v140, v140, v30
    v_mul_f32 v105, v143, v105
    v_mul_f32 v106, v143, v106
    v_mul_f32 v107, v143, v107
    v_mul_f32 v108, v143, v108
    v_mul_f32 v109, v143, v109
    v_mul_f32 v110, v143, v110
    v_mul_f32 v111, v143, v111
    v_cmp_nge_f32 vcc, v140, s3
    v_cmp_class_f32 s[22:23], v140, v141
    v_cvt_pk_bf16_f32 v104, v104, v105
    v_cvt_pk_bf16_f32 v105, v106, v107
    v_cvt_pk_bf16_f32 v106, v108, v109
    v_cvt_pk_bf16_f32 v107, v110, v111
    s_or_b64 vcc, vcc, s[22:23]
    s_cbranch_scc1 C_slow
    v_permlane32_swap_b32 v104, v106
    v_permlane32_swap_b32 v105, v107
    s_mov_b64 exec, s[30:31]
    buffer_store_dwordx4 v[104:107], v2, s[24:27], s50 offen offset:0 sc1
    s_mov_b32 exec_lo, -1
    s_mov_b32 exec_hi, 0
    buffer_store_dwordx2 v[106:107], v2, s[24:27], s50 offen offset:8 sc1
    s_mov_b64 exec, -1
C_st2:
    s_setprio 2
    s_cmp_ge_u32 s54, 28
    s_cbranch_scc1 C_exit
    ds_read_b64_tr_b16 v[4:5], v164 offset:0
    ds_read_b64_tr_b16 v[6:7], v164 offset:512
    ds_read_b64_tr_b16 v[8:9], v165 offset:0
    ds_read_b64_tr_b16 v[10:11], v165 offset:512
    ds_read_b64_tr_b16 v[12:13], v166 offset:0
    ds_read_b64_tr_b16 v[14:15], v166 offset:512
    ds_read_b64_tr_b16 v[16:17], v167 offset:0
    ds_read_b64_tr_b16 v[18:19], v167 offset:512
    ds_read_b64_tr_b16 v[20:21], v164 offset:4096
    ds_read_b64_tr_b16 v[22:23], v164 offset:4608
    ds_read_b64_tr_b16 v[24:25], v165 offset:4096
    ds_read_b64_tr_b16 v[26:27], v165 offset:4608
    ds_read_b64_tr_b16 v[28:29], v166 offset:4096
    ds_read_b64_tr_b16 v[30:31], v166 offset:4608
    ds_read_b64_tr_b16 v[32:33], v167 offset:4096
    ds_read_b64_tr_b16 v[34:35], v167 offset:4608
    ds_read_b64_tr_b16 v[36:37], v164 offset:8192
    ds_read_b64_tr_b16 v[38:39], v164 offset:8704
    ds_read_b64_tr_b16 v[40:41], v165 offset:8192
    ds_read_b64_tr_b16 v[42:43], v165 offset:8704
    ds_read_b64_tr_b16 v[44:45], v166 offset:8192
    ds_read_b64_tr_b16 v[46:47], v166 offset:8704
    ds_read_b64_tr_b16 v[48:49], v167 offset:8192
    ds_read_b64_tr_b16 v[50:51], v167 offset:8704
    ds_read_b64_tr_b16 v[52:53], v164 offset:12288
    ds_read_b64_tr_b16 v[54:55], v164 offset:12800
    ds_read_b64_tr_b16 v[56:57], v165 offset:12288
    ds_read_b64_tr_b16 v[58:59], v165 offset:12800
    ds_read_b64_tr_b16 v[60:61], v166 offset:12288
    ds_read_b64_tr_b16 v[62:63], v166 offset:12800
    ds_read_b64_tr_b16 v[64:65], v167 offset:12288
    ds_read_b64_tr_b16 v[66:67], v167 offset:12800
    ds_read_b64_tr_b16 v[68:69], v164 offset:16384
    ds_read_b64_tr_b16 v[70:71], v164 offset:16896
    ds_read_b64_tr_b16 v[72:73], v165 offset:16384
    ds_read_b64_tr_b16 v[74:75], v165 offset:16896
    ds_read_b64_tr_b16 v[76:77], v166 offset:16384
    ds_read_b64_tr_b16 v[78:79], v166 offset:16896
    ds_read_b64_tr_b16 v[80:81], v167 offset:16384
    ds_read_b64_tr_b16 v[82:83], v167 offset:16896
    s_mov_b32 s79, 262144
    s_mov_b32 s73, 0
    s_waitcnt vmcnt(0)
    s_mov_b32 s3, s49
    buffer_load_dwordx4 v[116:119], v162, s[24:27], s3 offen offset:0 sc1
    buffer_load_dwordx4 v[120:123], v162, s[24:27], s3 offen offset:2048 sc1
    s_add_u32 s3, s3, 4096
    buffer_load_dwordx4 v[124:127], v162, s[24:27], s3 offen offset:0 sc1
    buffer_load_dwordx4 v[128:131], v162, s[24:27], s3 offen offset:2048 sc1
    s_add_u32 s3, s3, 4096
    buffer_load_dwordx4 v[132:135], v162, s[24:27], s3 offen offset:0 sc1
    buffer_load_dwordx4 v[136:139], v162, s[24:27], s3 offen offset:2048 sc1
    s_add_u32 s3, s3, 4096
    buffer_load_dwordx4 v[140:143], v162, s[24:27], s3 offen offset:0 sc1
    ds_read_b64_tr_b16 v[84:85], v164 offset:20480
    ds_read_b64_tr_b16 v[86:87], v164 offset:20992
    ds_read_b64_tr_b16 v[88:89], v165 offset:20480
    ds_read_b64_tr_b16 v[90:91], v165 offset:20992
    ds_read_b64_tr_b16 v[92:93], v166 offset:20480
    ds_read_b64_tr_b16 v[94:95], v166 offset:20992
    ds_read_b64_tr_b16 v[96:97], v167 offset:20480
    ds_read_b64_tr_b16 v[98:99], v167 offset:20992
    ds_read_b64_tr_b16 v[100:101], v164 offset:24576
    ds_read_b64_tr_b16 v[102:103], v164 offset:25088
    ds_read_b64_tr_b16 v[104:105], v165 offset:24576
    ds_read_b64_tr_b16 v[106:107], v165 offset:25088
    ds_read_b64_tr_b16 v[108:109], v166 offset:24576
    ds_read_b64_tr_b16 v[110:111], v166 offset:25088
    ds_read_b64_tr_b16 v[112:113], v167 offset:24576
    ds_read_b64_tr_b16 v[114:115], v167 offset:25088
    v_mov_b32 v164, v153
    v_mov_b32 v165, v154
    v_mov_b32 v166, v156
    v_mov_b32 v167, v157
    s_waitcnt lgkmcnt(0)
C_pp:
    s_waitcnt vmcnt(6)
    v_mfma_f32_16x16x32_bf16 v[152:155], v[12:15], v[116:119], 0
    v_max3_u32 v3, v116, v117, v118
    v_mfma_f32_16x16x32_bf16 v[156:159], v[16:19], v[116:119], 0
    v_max3_u32 v3, v3, v118, v119
    v_mfma_f32_16x16x32_bf16 v[144:147], v[4:7], v[116:119], 0
    v_mfma_f32_16x16x32_bf16 v[148:151], v[8:11], v[116:119], 0
    s_waitcnt vmcnt(5)
    v_mfma_f32_16x16x32_bf16 v[152:155], v[28:31], v[120:123], v[152:155]
    v_max3_u32 v3, v120, v121, v3
    v_mfma_f32_16x16x32_bf16 v[156:159], v[32:35], v[120:123], v[156:159]
    v_max3_u32 v3, v3, v122, v123
    v_mfma_f32_16x16x32_bf16 v[144:147], v[20:23], v[120:123], v[144:147]
    v_mfma_f32_16x16x32_bf16 v[148:151], v[24:27], v[120:123], v[148:151]
    s_waitcnt vmcnt(4)
    v_mfma_f32_16x16x32_bf16 v[152:155], v[44:47], v[124:127], v[152:155]
    v_max3_u32 v3, v124, v125, v3
    v_mfma_f32_16x16x32_bf16 v[156:159], v[48:51], v[124:127], v[156:159]
    v_max3_u32 v3, v3, v126, v127
    v_mfma_f32_16x16x32_bf16 v[144:147], v[36:39], v[124:127], v[144:147]
    v_mfma_f32_16x16x32_bf16 v[148:151], v[40:43], v[124:127], v[148:151]
    s_waitcnt vmcnt(3)
    v_mfma_f32_16x16x32_bf16 v[152:155], v[60:63], v[128:131], v[152:155]
    v_max3_u32 v3, v128, v129, v3
    v_mfma_f32_16x16x32_bf16 v[156:159], v[64:67], v[128:131], v[156:159]
    v_max3_u32 v3, v3, v130, v131
    v_mfma_f32_16x16x32_bf16 v[144:147], v[52:55], v[128:131], v[144:147]
    v_mfma_f32_16x16x32_bf16 v[148:151], v[56:59], v[128:131], v[148:151]
    s_waitcnt vmcnt(2)
    v_mfma_f32_16x16x32_bf16 v[152:155], v[76:79], v[132:135], v[152:155]
    v_max3_u32 v3, v132, v133, v3
    v_mfma_f32_16x16x32_bf16 v[156:159], v[80:83], v[132:135], v[156:159]
    v_max3_u32 v3, v3, v134, v135
    v_mfma_f32_16x16x32_bf16 v[144:147], v[68:71], v[132:135], v[144:147]
    v_mfma_f32_16x16x32_bf16 v[148:151], v[72:75], v[132:135], v[148:151]
    s_waitcnt vmcnt(1)
    v_mfma_f32_16x16x32_bf16 v[152:155], v[92:95], v[136:139], v[152:155]
    v_max3_u32 v3, v136, v137, v3
    v_mfma_f32_16x16x32_bf16 v[156:159], v[96:99], v[136:139], v[156:159]
    v_max3_u32 v3, v3, v138, v139
    v_mfma_f32_16x16x32_bf16 v[144:147], v[84:87], v[136:139], v[144:147]
    v_mfma_f32_16x16x32_bf16 v[148:151], v[88:91], v[136:139], v[148:151]
    s_waitcnt vmcnt(0)
    v_mfma_f32_16x16x32_bf16 v[152:155], v[108:111], v[140:143], v[152:155]
    v_max3_u32 v3, v140, v141, v3
    v_mfma_f32_16x16x32_bf16 v[156:159], v[112:115], v[140:143], v[156:159]
    v_max3_u32 v3, v3, v142, v143
    v_mfma_f32_16x16x32_bf16 v[144:147], v[100:103], v[140:143], v[144:147]
    v_mfma_f32_16x16x32_bf16 v[148:151], v[104:107], v[140:143], v[148:151]
    v_cmp_eq_u32 vcc, -1, v3
    s_add_u32 s73, s73, 1
    s_cmp_lg_u64 vcc, 0
    s_cbranch_scc1 C_again
C_ppx:
    s_nop 0
    ds_write_b128 v166, v[152:155]
    ds_write_b128 v167, v[156:159]
    s_waitcnt lgkmcnt(0)
    s_barrier
    ds_read_b128 v[116:119], v164
    ds_read_b128 v[120:123], v165
    s_waitcnt lgkmcnt(0)
    v_add_f32 v144, v144, v116
    v_add_f32 v145, v145, v117
    v_add_f32 v146, v146, v118
    v_add_f32 v147, v147, v119
    v_add_f32 v148, v148, v120
    v_add_f32 v149, v149, v121
    v_add_f32 v150, v150, v122
    v_add_f32 v151, v151, v123
    v_cvt_pk_bf16_f32 v144, v144, v145
    v_cvt_pk_bf16_f32 v145, v146, v147
    v_cvt_pk_bf16_f32 v146, v148, v149
    v_cvt_pk_bf16_f32 v147, v150, v151
    s_nop 1
    v_permlane16_swap_b32 v144, v146
    v_permlane16_swap_b32 v145, v147
    buffer_store_dwordx4 v[144:147], v161, s[36:39], s48 offen nt
C_exit:
    s_endpgm
C_k1:
    s_cmp_lg_u32 s61, 0
    s_cselect_b64 s[28:29], -1, 0
    s_cmp_lg_u32 s61, 1
    s_cselect_b32 s30, -1, -1
    s_cselect_b32 s31, 0, -1
    s_mov_b32 s3, 0xd800000
    v_mov_b32 v141, 0x207
    s_nop 2
    ds_write_b128 v153, v[104:107]
    v_mov_b32 v142, v116
    ds_write_b128 v154, v[108:111]
    s_mov_b64 exec, s[28:29]
    v_mov_b32 v142, v104
    s_mov_b64 exec, -1
    ds_write_b32 v155, v142
    s_waitcnt lgkmcnt(0)
    s_barrier
    ds_read_b32 v36, v158
    ds_read_b128 v[28:31], v156
    ds_read_b128 v[32:35], v157
    s_waitcnt lgkmcnt(2)
    v_add_f32 v142, v142, v36
    v_mov_b32 v143, v142
    s_nop 1
    v_permlane32_swap_b32 v143, v142
    s_mov_b64 exec, s[28:29]
    v_mov_b32 v142, v143
    s_mov_b64 exec, -1
    v_rcp_f32 v143, v142
    v_mul_f32 v140, 0, v142
    s_waitcnt lgkmcnt(0)
    v_add_f32 v112, v112, v28
    v_add_f32 v113, v113, v29
    v_add_f32 v114, v114, v30
    v_add_f32 v115, v115, v31
    v_add_f32 v116, v116, v32
    v_add_f32 v117, v117, v33
    v_add_f32 v118, v118, v34
    v_add_f32 v119, v119, v35
    v_add_f32 v28, abs(v112), abs(v113)
    v_add_f32 v29, abs(v114), abs(v115)
    v_add_f32 v30, abs(v116), abs(v117)
    v_add_f32 v31, abs(v118), abs(v119)
    v_add_f32 v28, v28, v29
    v_add_f32 v30, v30, v31
    v_add_f32 v140, v140, v28
    v_mul_f32 v112, v143, v112
    v_add_f32 v140, v140, v30
    v_mul_f32 v113, v143, v113
    v_mul_f32 v114, v143, v114
    v_mul_f32 v115, v143, v115
    v_mul_f32 v116, v143, v116
    v_mul_f32 v117, v143, v117
    v_mul_f32 v118, v143, v118
    v_mul_f32 v119, v143, v119
    v_cmp_nge_f32 vcc, v140, s3
    v_cmp_class_f32 s[22:23], v140, v141
    v_cvt_pk_bf16_f32 v112, v112, v113
    v_cvt_pk_bf16_f32 v113, v114, v115
    v_cvt_pk_bf16_f32 v114, v116, v117
    v_cvt_pk_bf16_f32 v115, v118, v119
    s_or_b64 vcc, vcc, s[22:23]
    s_cbranch_scc1 C_slow
    v_permlane32_swap_b32 v112, v114
    v_permlane32_swap_b32 v113, v115
    s_mov_b64 exec, s[30:31]
    buffer_store_dwordx4 v[112:115], v2, s[24:27], s50 offen offset:1024 sc1
    s_mov_b32 exec_lo, 0
    s_mov_b32 exec_hi, -1
    buffer_store_dwordx2 v[112:113], v2, s[24:27], s50 offen offset:1024 sc1
    s_mov_b64 exec, -1
    s_branch C_st2
C_again:
    s_sub_u32 s79, s79, 1
    s_cbranch_scc1 C_ppx
    s_mov_b32 s3, s49
    buffer_load_dwordx4 v[116:119], v162, s[24:27], s3 offen offset:0 sc1
    buffer_load_dwordx4 v[120:123], v162, s[24:27], s3 offen offset:2048 sc1
    s_add_u32 s3, s3, 4096
    buffer_load_dwordx4 v[124:127], v162, s[24:27], s3 offen offset:0 sc1
    buffer_load_dwordx4 v[128:131], v162, s[24:27], s3 offen offset:2048 sc1
    s_add_u32 s3, s3, 4096
    buffer_load_dwordx4 v[132:135], v162, s[24:27], s3 offen offset:0 sc1
    buffer_load_dwordx4 v[136:139], v162, s[24:27], s3 offen offset:2048 sc1
    s_add_u32 s3, s3, 4096
    buffer_load_dwordx4 v[140:143], v162, s[24:27], s3 offen offset:0 sc1
    s_branch C_pp
C_slow:
    v_mov_b32 v140, 0xff800000
    s_mov_b32 s68, 0
C_s1:
    s_mul_i32 s69, s68, 28672
    s_lshl_b32 s3, s60, 7
    s_add_u32 s70, s69, s3
    s_add_u32 s70, s70, 11010048
    s_lshl_b32 s3, s60, 9
    s_add_u32 s69, s69, s3
    s_add_u32 s69, s69, 9175040
    buffer_load_dwordx4 v[120:123], v2, s[24:27], s69 offen sc1
    buffer_load_dwordx4 v[124:127], v2, s[24:27], s69 offen offset:1024 sc1
    s_waitcnt vmcnt(0)
    v_mfma_f32_32x32x16_bf16 v[28:43], v[120:123], v[4:7], 0
    v_mfma_f32_32x32x16_bf16 v[28:43], v[124:127], v[8:11], v[28:43]
    s_nop 15
    v_max3_f32 v140, v140, v28, v29
    v_max3_f32 v140, v140, v30, v31
    v_max3_f32 v140, v140, v32, v33
    v_max3_f32 v140, v140, v34, v35
    v_max3_f32 v140, v140, v36, v37
    v_max3_f32 v140, v140, v38, v39
    v_max3_f32 v140, v140, v40, v41
    v_max3_f32 v140, v140, v42, v43
    s_add_u32 s68, s68, 1
    s_cmp_lt_u32 s68, 64
    s_cbranch_scc1 C_s1
    v_mov_b32 v141, v140
    s_nop 1
    v_permlane32_swap_b32 v140, v141
    s_nop 1
    v_max_f32 v140, v140, v141
    v_lshrrev_b32 v141, 5, v0
    v_mul_u32_u24 v141, 6656, v141
    v_add_u32 v141, v141, v2
    v_mov_b32 v104, 0
    v_mov_b32 v105, 0
    v_mov_b32 v106, 0
    v_mov_b32 v107, 0
    v_mov_b32 v108, 0
    v_mov_b32 v109, 0
    v_mov_b32 v110, 0
    v_mov_b32 v111, 0
    v_mov_b32 v112, 0
    v_mov_b32 v113, 0
    v_mov_b32 v114, 0
    v_mov_b32 v115, 0
    v_mov_b32 v116, 0
    v_mov_b32 v117, 0
    v_mov_b32 v118, 0
    v_mov_b32 v119, 0
    v_mov_b32 v128, 0x3f803f80
    v_mov_b32 v129, 0x3f803f80
    v_mov_b32 v130, 0x3f803f80
    v_mov_b32 v131, 0x3f803f80
    v_mov_b32 v132, 0x3f803f80
    v_mov_b32 v133, 0x3f803f80
    v_mov_b32 v134, 0x3f803f80
    v_mov_b32 v135, 0x3f803f80
    s_mov_b32 s68, 0
C_s2:
    s_mul_i32 s69, s68, 28672
    s_lshl_b32 s3, s60, 7
    s_add_u32 s70, s69, s3
    s_add_u32 s70, s70, 11010048
    s_lshl_b32 s3, s60, 9
    s_add_u32 s69, s69, s3
    s_add_u32 s69, s69, 9175040
    buffer_load_dwordx4 v[120:123], v2, s[24:27], s69 offen sc1
    buffer_load_dwordx4 v[124:127], v2, s[24:27], s69 offen offset:1024 sc1
    s_add_u32 s3, s70, 14336
    s_mov_b64 exec, s[66:67]
    buffer_load_dwordx4 v[128:131], v141, s[24:27], s70 offen sc1
    buffer_load_dwordx4 v[132:135], v141, s[24:27], s3 offen sc1
    s_mov_b64 exec, -1
    s_waitcnt vmcnt(0)
    v_mfma_f32_32x32x16_bf16 v[28:43], v[120:123], v[4:7], 0
    v_mfma_f32_32x32x16_bf16 v[28:43], v[124:127], v[8:11], v[28:43]
    s_nop 15
    v_sub_f32 v28, v28, v140
    v_sub_f32 v29, v29, v140
    v_sub_f32 v30, v30, v140
    v_sub_f32 v31, v31, v140
    v_sub_f32 v32, v32, v140
    v_sub_f32 v33, v33, v140
    v_sub_f32 v34, v34, v140
    v_sub_f32 v35, v35, v140
    v_sub_f32 v36, v36, v140
    v_sub_f32 v37, v37, v140
    v_sub_f32 v38, v38, v140
    v_sub_f32 v39, v39, v140
    v_sub_f32 v40, v40, v140
    v_sub_f32 v41, v41, v140
    v_sub_f32 v42, v42, v140
    v_sub_f32 v43, v43, v140
    v_exp_f32 v28, v28
    v_exp_f32 v29, v29
    v_exp_f32 v30, v30
    v_exp_f32 v31, v31
    v_exp_f32 v32, v32
    v_exp_f32 v33, v33
    v_exp_f32 v34, v34
    v_exp_f32 v35, v35
    v_exp_f32 v36, v36
    v_exp_f32 v37, v37
    v_exp_f32 v38, v38
    v_exp_f32 v39, v39
    v_exp_f32 v40, v40
    v_exp_f32 v41, v41
    v_exp_f32 v42, v42
    v_exp_f32 v43, v43
    s_nop 0
    v_cvt_pk_bf16_f32 v60, v28, v29
    v_cvt_pk_bf16_f32 v61, v30, v31
    v_cvt_pk_bf16_f32 v62, v32, v33
    v_cvt_pk_bf16_f32 v63, v34, v35
    v_cvt_pk_bf16_f32 v64, v36, v37
    v_cvt_pk_bf16_f32 v65, v38, v39
    v_cvt_pk_bf16_f32 v66, v40, v41
    v_cvt_pk_bf16_f32 v67, v42, v43
    s_nop 1
    v_mfma_f32_32x32x16_bf16 v[104:119], v[128:131], v[60:63], v[104:119]
    v_mfma_f32_32x32x16_bf16 v[104:119], v[132:135], v[64:67], v[104:119]
    s_add_u32 s68, s68, 1
    s_cmp_lt_u32 s68, 64
    s_nop 15
    s_cbranch_scc1 C_s2
    s_cmp_eq_u32 s61, 0
    s_cbranch_scc1 bl_4_e
    v_mov_b32 v144, v104
    v_mov_b32 v145, v104
    s_nop 1
    v_permlane32_swap_b32 v144, v145
    s_branch bl_4_x
bl_4_e:
    v_mov_b32 v144, v116
    v_mov_b32 v145, v116
    s_nop 1
    v_permlane32_swap_b32 v145, v144
bl_4_x:
    s_nop 1
    s_cmp_eq_u32 s77, 0
    s_cbranch_scc1 C_fin
    v_mov_b32 v104, v112
    v_mov_b32 v105, v113
    v_mov_b32 v106, v114
    v_mov_b32 v107, v115
    v_mov_b32 v108, v116
    v_mov_b32 v109, v117
    v_mov_b32 v110, v118
    v_mov_b32 v111, v119
C_fin:
    v_rcp_f32 v144, v144
    s_nop 0
    v_mul_f32 v104, v144, v104
    v_mul_f32 v105, v144, v105
    v_mul_f32 v106, v144, v106
    v_mul_f32 v107, v144, v107
    v_mul_f32 v108, v144, v108
    v_mul_f32 v109, v144, v109
    v_mul_f32 v110, v144, v110
    v_mul_f32 v111, v144, v111
    v_cvt_pk_bf16_f32 v104, v104, v105
    v_cvt_pk_bf16_f32 v105, v106, v107
    v_cvt_pk_bf16_f32 v106, v108, v109
    v_cvt_pk_bf16_f32 v107, v110, v111
    s_nop 1
    v_permlane32_swap_b32 v104, v106
    v_permlane32_swap_b32 v105, v107
    s_cmp_eq_u32 s77, 0
    s_cbranch_scc0 C_st1
    s_cmp_eq_u32 s61, 0
    s_cbranch_scc1 su_5_f
    s_mov_b32 exec_hi, 0
    buffer_store_dwordx2 v[106:107], v2, s[24:27], s50 offen offset:8 sc1
    s_not_b64 exec, exec
su_5_f:
    buffer_store_dwordx4 v[104:107], v2, s[24:27], s50 offen offset:0 sc1
    s_mov_b64 exec, -1
    s_branch C_st2
C_st1:
    s_cmp_eq_u32 s61, 1
    s_cbranch_scc1 su_6_f
    s_mov_b32 exec_lo, 0
    buffer_store_dwordx2 v[104:105], v2, s[24:27], s50 offen offset:1024 sc1
    s_not_b64 exec, exec
su_6_f:
    buffer_store_dwordx4 v[104:107], v2, s[24:27], s50 offen offset:1024 sc1
    s_mov_b64 exec, -1
    s_branch C_st2
L_helper:
    s_setprio 3
    s_barrier
    s_mul_i32 s68, s10, 28672
    s_add_u32 m0, s11, 98304
    s_add_u32 s22, s68, s8
    s_add_u32 s22, s22, 9175040
    buffer_load_dwordx4 v2, s[24:27], s22 offen sc1 lds
    s_add_u32 s23, s22, 26624
    buffer_load_dwordx4 v2, s[24:27], s22 offen offset:1024 sc1 lds
    s_add_u32 s68, s68, s9
    buffer_load_dwordx4 v2, s[24:27], s23 offen offset:2048 sc1 lds
    s_add_u32 s68, s68, 11010048
    buffer_load_dwordx4 v2, s[24:27], s23 offen offset:3072 sc1 lds
    s_add_u32 m0, s11, 114688
    s_mov_b64 exec, s[66:67]
    buffer_load_dwordx4 v15, s[24:27], s68 offen offset:0 sc1 lds
    s_add_u32 s68, s68, 13312
    buffer_load_dwordx4 v15, s[24:27], s68 offen offset:1024 sc1 lds
    s_add_u32 s68, s68, 13312
    buffer_load_dwordx4 v15, s[24:27], s68 offen offset:2048 sc1 lds
    s_add_u32 s68, s68, 13312
    buffer_load_dwordx4 v15, s[24:27], s68 offen offset:3072 sc1 lds
    s_not_b64 exec, exec
    global_load_lds_dwordx4 v9, s[18:19]
    s_add_u32 m0, s11, 115712
    s_nop 0
    global_load_lds_dwordx4 v9, s[18:19]
    s_add_u32 m0, s11, 116736
    s_nop 0
    global_load_lds_dwordx4 v9, s[18:19]
    s_add_u32 m0, s11, 117760
    s_nop 0
    global_load_lds_dwordx4 v9, s[18:19]
    s_mov_b64 exec, -1
    s_add_u32 s10, s10, 8
    s_and_b32 s10, s10, 63
    buffer_store_dwordx4 v[96:99], v15, s[24:27], s71 offen sc1
    buffer_store_dwordx4 v[100:103], v15, s[24:27], s72 offen sc1
    buffer_store_dwordx4 v[88:91], v2, s[24:27], s70 offen sc1
    s_mul_i32 s78, s12, 28672
    s_add_u32 s78, s78, s8
    s_lshl_b32 s16, s73, 7
    s_add_u32 s16, s16, 14712832
    v_mov_b32 v64, -1
    v_mov_b32 v65, -1
    v_mov_b32 v66, -1
    v_mov_b32 v67, -1
    s_add_u32 s13, s78, 12845056
    s_waitcnt vmcnt(3)
    s_barrier
    s_mul_i32 s68, s10, 28672
    s_add_u32 m0, s11, 65536
    s_add_u32 s22, s68, s8
    s_add_u32 s22, s22, 9175040
    buffer_load_dwordx4 v2, s[24:27], s22 offen sc1 lds
    s_add_u32 s23, s22, 26624
    buffer_load_dwordx4 v2, s[24:27], s22 offen offset:1024 sc1 lds
    s_add_u32 s68, s68, s9
    buffer_load_dwordx4 v2, s[24:27], s23 offen offset:2048 sc1 lds
    s_add_u32 s68, s68, 11010048
    buffer_load_dwordx4 v2, s[24:27], s23 offen offset:3072 sc1 lds
    s_add_u32 m0, s11, 81920
    s_mov_b64 exec, s[66:67]
    buffer_load_dwordx4 v15, s[24:27], s68 offen offset:0 sc1 lds
    s_add_u32 s68, s68, 13312
    buffer_load_dwordx4 v15, s[24:27], s68 offen offset:1024 sc1 lds
    s_add_u32 s68, s68, 13312
    buffer_load_dwordx4 v15, s[24:27], s68 offen offset:2048 sc1 lds
    s_add_u32 s68, s68, 13312
    buffer_load_dwordx4 v15, s[24:27], s68 offen offset:3072 sc1 lds
    s_not_b64 exec, exec
    global_load_lds_dwordx4 v9, s[18:19]
    s_add_u32 m0, s11, 82944
    s_nop 0
    global_load_lds_dwordx4 v9, s[18:19]
    s_add_u32 m0, s11, 83968
    s_nop 0
    global_load_lds_dwordx4 v9, s[18:19]
    s_add_u32 m0, s11, 84992
    s_nop 0
    global_load_lds_dwordx4 v9, s[18:19]
    s_mov_b64 exec, -1
    s_add_u32 s10, s10, 8
    s_and_b32 s10, s10, 63
    buffer_store_dwordx4 v[92:95], v2, s[24:27], s70 offen offset:1024 sc1
    buffer_store_dwordx4 v[80:83], v2, s[24:27], s69 offen sc1
    buffer_store_dwordx4 v[84:87], v2, s[24:27], s69 offen offset:1024 sc1
    s_waitcnt vmcnt(3)
    s_barrier
    s_mul_i32 s68, s10, 28672
    s_add_u32 m0, s11, 131072
    s_add_u32 s22, s68, s8
    s_add_u32 s22, s22, 9175040
    buffer_load_dwordx4 v2, s[24:27], s22 offen sc1 lds
    s_add_u32 s23, s22, 26624
    buffer_load_dwordx4 v2, s[24:27], s22 offen offset:1024 sc1 lds
    s_add_u32 s68, s68, s9
    buffer_load_dwordx4 v2, s[24:27], s23 offen offset:2048 sc1 lds
    s_add_u32 s68, s68, 11010048
    buffer_load_dwordx4 v2, s[24:27], s23 offen offset:3072 sc1 lds
    s_add_u32 m0, s11, 147456
    s_mov_b64 exec, s[66:67]
    buffer_load_dwordx4 v15, s[24:27], s68 offen offset:0 sc1 lds
    s_add_u32 s68, s68, 13312
    buffer_load_dwordx4 v15, s[24:27], s68 offen offset:1024 sc1 lds
    s_add_u32 s68, s68, 13312
    buffer_load_dwordx4 v15, s[24:27], s68 offen offset:2048 sc1 lds
    s_add_u32 s68, s68, 13312
    buffer_load_dwordx4 v15, s[24:27], s68 offen offset:3072 sc1 lds
    s_mov_b64 exec, -1
    s_add_u32 s10, s10, 8
    s_and_b32 s10, s10, 63
    s_waitcnt vmcnt(8)
    v_mov_b32 v104, s64
    v_mov_b32 v105, s65
    s_mov_b64 exec, 1
    buffer_store_dwordx2 v[104:105], v2, s[24:27], s16 offen sc1
    s_mov_b64 exec, -1
    s_cmp_eq_u32 s61, 0
    s_cbranch_scc1 su_7_f
    s_mov_b32 exec_hi, 0
    buffer_store_dwordx2 v[66:67], v2, s[24:27], s13 offen offset:8 sc1
    s_not_b64 exec, exec
su_7_f:
    buffer_store_dwordx4 v[64:67], v2, s[24:27], s13 offen offset:0 sc1
    s_mov_b64 exec, -1
    s_cmp_eq_u32 s61, 1
    s_cbranch_scc1 su_8_f
    s_mov_b32 exec_lo, 0
    buffer_store_dwordx2 v[64:65], v2, s[24:27], s13 offen offset:1024 sc1
    s_not_b64 exec, exec
su_8_f:
    buffer_store_dwordx4 v[64:67], v2, s[24:27], s13 offen offset:1024 sc1
    s_mov_b64 exec, -1
    s_waitcnt vmcnt(4)
    s_barrier
    s_mul_i32 s68, s10, 28672
    s_add_u32 m0, s11, 98304
    s_add_u32 s22, s68, s8
    s_add_u32 s22, s22, 9175040
    buffer_load_dwordx4 v2, s[24:27], s22 offen sc1 lds
    s_add_u32 s23, s22, 26624
    buffer_load_dwordx4 v2, s[24:27], s22 offen offset:1024 sc1 lds
    s_add_u32 s68, s68, s9
    buffer_load_dwordx4 v2, s[24:27], s23 offen offset:2048 sc1 lds
    s_add_u32 s68, s68, 11010048
    buffer_load_dwordx4 v2, s[24:27], s23 offen offset:3072 sc1 lds
    s_add_u32 m0, s11, 114688
    s_mov_b64 exec, s[66:67]
    buffer_load_dwordx4 v15, s[24:27], s68 offen offset:0 sc1 lds
    s_add_u32 s68, s68, 13312
    buffer_load_dwordx4 v15, s[24:27], s68 offen offset:1024 sc1 lds
    s_add_u32 s68, s68, 13312
    buffer_load_dwordx4 v15, s[24:27], s68 offen offset:2048 sc1 lds
    s_add_u32 s68, s68, 13312
    buffer_load_dwordx4 v15, s[24:27], s68 offen offset:3072 sc1 lds
    s_mov_b64 exec, -1
    s_add_u32 s10, s10, 8
    s_and_b32 s10, s10, 63
    s_mov_b32 s79, 262144
poll_9:
    buffer_load_dwordx2 v[104:105], v17, s[24:27], 0 offen sc1
    s_waitcnt vmcnt(0)
    v_cmp_ne_u64 vcc, s[64:65], v[104:105]
    s_sub_u32 s79, s79, 1
    s_cbranch_scc1 poll_9_x
    s_cmp_eq_u64 vcc, 0
    s_cbranch_scc1 poll_9_x
    s_mov_b64 exec, vcc
    s_sleep 1
    s_branch poll_9
poll_9_x:
    s_mov_b64 exec, -1
    s_mul_i32 s68, s12, 28672
    s_cmp_eq_u32 s12, 0
    s_cselect_b32 s3, 0, 28672
    s_sub_u32 s69, s68, s3
    s_add_u32 s70, s78, 1835008
    s_add_u32 s71, s69, s8
    s_add_u32 s71, s71, 1835008
    buffer_load_dwordx4 v[28:31], v2, s[24:27], s78 offen sc1
    buffer_load_dwordx4 v[32:35], v2, s[24:27], s78 offen offset:1024 sc1
    buffer_load_dwordx4 v[44:47], v2, s[24:27], s70 offen sc1
    buffer_load_dwordx4 v[48:51], v2, s[24:27], s70 offen offset:1024 sc1
    buffer_load_dwordx4 v[36:39], v2, s[24:27], s71 offen sc1
    buffer_load_dwordx4 v[40:43], v2, s[24:27], s71 offen offset:1024 sc1
    s_add_u32 s68, s68, s9
    s_add_u32 s68, s68, 3670016
    s_add_u32 s70, s68, 14336
    s_add_u32 s69, s69, s9
    s_add_u32 s69, s69, 3684352
    buffer_load_dwordx4 v[56:59], v15, s[24:27], s68 offen sc1
    buffer_load_dwordx4 v[60:63], v15, s[24:27], s70 offen sc1
    buffer_load_dwordx4 v[52:55], v15, s[24:27], s69 offen sc1
    s_barrier
    s_mul_i32 s68, s10, 28672
    s_add_u32 m0, s11, 65536
    s_add_u32 s22, s68, s8
    s_add_u32 s22, s22, 9175040
    buffer_load_dwordx4 v2, s[24:27], s22 offen sc1 lds
    s_add_u32 s23, s22, 26624
    buffer_load_dwordx4 v2, s[24:27], s22 offen offset:1024 sc1 lds
    s_add_u32 s68, s68, s9
    buffer_load_dwordx4 v2, s[24:27], s23 offen offset:2048 sc1 lds
    s_add_u32 s68, s68, 11010048
    buffer_load_dwordx4 v2, s[24:27], s23 offen offset:3072 sc1 lds
    s_add_u32 m0, s11, 81920
    s_mov_b64 exec, s[66:67]
    buffer_load_dwordx4 v15, s[24:27], s68 offen offset:0 sc1 lds
    s_add_u32 s68, s68, 13312
    buffer_load_dwordx4 v15, s[24:27], s68 offen offset:1024 sc1 lds
    s_add_u32 s68, s68, 13312
    buffer_load_dwordx4 v15, s[24:27], s68 offen offset:2048 sc1 lds
    s_add_u32 s68, s68, 13312
    buffer_load_dwordx4 v15, s[24:27], s68 offen offset:3072 sc1 lds
    s_mov_b64 exec, -1
    s_add_u32 s10, s10, 8
    s_and_b32 s10, s10, 63
    s_waitcnt vmcnt(8)
    s_cmp_eq_u32 s61, 0
    s_cbranch_scc1 zf_10_e
    s_mov_b32 exec_hi, 0
    v_mov_b32 v28, 0
    v_mov_b32 v29, 0
    s_branch zf_10_x
zf_10_e:
    s_mov_b32 exec_lo, 0
    v_mov_b32 v34, 0
    v_mov_b32 v35, 0
zf_10_x:
    s_mov_b64 exec, -1
    s_nop 0
    v_mfma_f32_32x32x16_bf16 v[108:123], v[36:39], v[28:31], 0
    v_mfma_f32_32x32x16_bf16 v[124:139], v[44:47], v[28:31], 0
    v_mfma_f32_32x32x16_bf16 v[108:123], v[40:43], v[32:35], v[108:123]
    v_mfma_f32_32x32x16_bf16 v[124:139], v[48:51], v[32:35], v[124:139]
    s_nop 11
    v_bitop3_b32 v116, v24, v117, v116 bitop3:0xca
    v_bitop3_b32 v118, v24, v119, v118 bitop3:0xca
    v_bitop3_b32 v120, v24, v121, v120 bitop3:0xca
    v_bitop3_b32 v122, v24, v123, v122 bitop3:0xca
    v_bitop3_b32 v124, v24, v125, v124 bitop3:0xca
    v_bitop3_b32 v126, v24, v127, v126 bitop3:0xca
    v_bitop3_b32 v128, v24, v129, v128 bitop3:0xca
    v_bitop3_b32 v130, v24, v131, v130 bitop3:0xca
    v_bitop3_b32 v132, v24, v133, v132 bitop3:0xca
    v_bitop3_b32 v134, v24, v135, v134 bitop3:0xca
    v_bitop3_b32 v136, v24, v137, v136 bitop3:0xca
    v_bitop3_b32 v138, v24, v139, v138 bitop3:0xca
    v_bitop3_b32 v156, v116, v144, v156 bitop3:0xea
    v_bitop3_b32 v157, v118, v145, v157 bitop3:0xea
    v_bitop3_b32 v158, v120, v146, v158 bitop3:0xea
    v_bitop3_b32 v159, v122, v147, v159 bitop3:0xea
    v_bitop3_b32 v156, v124, v148, v156 bitop3:0xea
    v_bitop3_b32 v157, v126, v149, v157 bitop3:0xea
    v_bitop3_b32 v158, v128, v150, v158 bitop3:0xea
    v_bitop3_b32 v159, v130, v151, v159 bitop3:0xea
    v_bitop3_b32 v156, v132, v152, v156 bitop3:0xea
    v_bitop3_b32 v157, v134, v153, v157 bitop3:0xea
    v_bitop3_b32 v158, v136, v154, v158 bitop3:0xea
    v_bitop3_b32 v159, v138, v155, v159 bitop3:0xea
    v_max3_f32 v104, v156, v157, v158
    v_max_f32 v104, v104, v159
    v_mov_b32 v105, v104
    s_nop 1
    v_permlane32_swap_b32 v104, v105
    s_nop 1
    v_max_f32 v104, v104, v105
    v_sub_f32 v156, v156, v104
    v_sub_f32 v157, v157, v104
    v_sub_f32 v158, v158, v104
    v_sub_f32 v159, v159, v104
    v_exp_f32 v156, v156
    v_exp_f32 v157, v157
    v_exp_f32 v158, v158
    v_exp_f32 v159, v159
    s_nop 0
    v_add_f32 v104, v156, v157
    v_add_f32 v105, v158, v159
    v_add_f32 v104, v104, v105
    v_mov_b32 v105, v104
    s_nop 1
    v_permlane32_swap_b32 v104, v105
    s_nop 1
    v_add_f32 v104, v104, v105
    v_rcp_f32 v104, v104
    s_nop 0
    v_mul_f32 v156, v156, v104
    v_mul_f32 v157, v157, v104
    v_mul_f32 v158, v158, v104
    v_mul_f32 v159, v159, v104
    v_cvt_pk_bf16_f32 v156, v156, v156
    v_cvt_pk_bf16_f32 v157, v157, v157
    v_cvt_pk_bf16_f32 v158, v158, v158
    v_cvt_pk_bf16_f32 v159, v159, v159
    v_bitop3_b32 v144, v144, v156, v25 bitop3:0x80
    v_bitop3_b32 v145, v145, v157, v25 bitop3:0x80
    v_bitop3_b32 v146, v146, v158, v25 bitop3:0x80
    v_bitop3_b32 v147, v147, v159, v25 bitop3:0x80
    v_bitop3_b32 v148, v148, v156, v25 bitop3:0x80
    v_bitop3_b32 v149, v149, v157, v25 bitop3:0x80
    v_bitop3_b32 v150, v150, v158, v25 bitop3:0x80
    v_bitop3_b32 v151, v151, v159, v25 bitop3:0x80
    v_bitop3_b32 v152, v152, v156, v25 bitop3:0x80
    v_bitop3_b32 v153, v153, v157, v25 bitop3:0x80
    v_bitop3_b32 v154, v154, v158, v25 bitop3:0x80
    v_bitop3_b32 v155, v155, v159, v25 bitop3:0x80
    s_nop 1
    v_mfma_f32_32x32x16_bf16 v[108:123], v[52:55], v[144:147], 0
    v_mfma_f32_32x32x16_bf16 v[108:123], v[56:59], v[148:151], v[108:123]
    v_mfma_f32_32x32x16_bf16 v[108:123], v[60:63], v[152:155], v[108:123]
    s_add_u32 s78, s78, 5505024
    s_nop 11
    v_cvt_pk_bf16_f32 v108, v108, v109
    v_cvt_pk_bf16_f32 v109, v110, v111
    v_cvt_pk_bf16_f32 v110, v112, v113
    v_cvt_pk_bf16_f32 v111, v114, v115
    v_cvt_pk_bf16_f32 v112, v116, v117
    v_cvt_pk_bf16_f32 v113, v118, v119
    v_cvt_pk_bf16_f32 v114, v120, v121
    v_cvt_pk_bf16_f32 v115, v122, v123
    s_nop 1
    v_permlane32_swap_b32 v108, v110
    v_permlane32_swap_b32 v109, v111
    v_permlane32_swap_b32 v112, v114
    v_permlane32_swap_b32 v113, v115
    s_cmp_eq_u32 s61, 0
    s_cbranch_scc1 su_11_f
    s_mov_b32 exec_hi, 0
    buffer_store_dwordx2 v[110:111], v2, s[24:27], s78 offen offset:8 sc1
    s_not_b64 exec, exec
su_11_f:
    buffer_store_dwordx4 v[108:111], v2, s[24:27], s78 offen offset:0 sc1
    s_mov_b64 exec, -1
    s_cmp_eq_u32 s61, 1
    s_cbranch_scc1 su_12_f
    s_mov_b32 exec_lo, 0
    buffer_store_dwordx2 v[112:113], v2, s[24:27], s78 offen offset:1024 sc1
    s_not_b64 exec, exec
su_12_f:
    buffer_store_dwordx4 v[112:115], v2, s[24:27], s78 offen offset:1024 sc1
    s_mov_b64 exec, -1
    s_waitcnt vmcnt(3)
    s_barrier
    s_mul_i32 s68, s10, 28672
    s_add_u32 m0, s11, 131072
    s_add_u32 s22, s68, s8
    s_add_u32 s22, s22, 9175040
    buffer_load_dwordx4 v2, s[24:27], s22 offen sc1 lds
    s_add_u32 s23, s22, 26624
    buffer_load_dwordx4 v2, s[24:27], s22 offen offset:1024 sc1 lds
    s_add_u32 s68, s68, s9
    buffer_load_dwordx4 v2, s[24:27], s23 offen offset:2048 sc1 lds
    s_add_u32 s68, s68, 11010048
    buffer_load_dwordx4 v2, s[24:27], s23 offen offset:3072 sc1 lds
    s_add_u32 m0, s11, 147456
    s_mov_b64 exec, s[66:67]
    buffer_load_dwordx4 v15, s[24:27], s68 offen offset:0 sc1 lds
    s_add_u32 s68, s68, 13312
    buffer_load_dwordx4 v15, s[24:27], s68 offen offset:1024 sc1 lds
    s_add_u32 s68, s68, 13312
    buffer_load_dwordx4 v15, s[24:27], s68 offen offset:2048 sc1 lds
    s_add_u32 s68, s68, 13312
    buffer_load_dwordx4 v15, s[24:27], s68 offen offset:3072 sc1 lds
    s_mov_b64 exec, -1
    s_add_u32 s10, s10, 8
    s_and_b32 s10, s10, 63
    s_lshl_b32 s3, s12, 4
    s_add_u32 s3, s3, s58
    s_lshl_b32 s3, s3, 7
    s_add_u32 s78, s3, 14843904
    s_waitcnt vmcnt(8)
    v_mov_b32 v104, s64
    v_mov_b32 v105, s65
    s_mov_b64 exec, 1
    buffer_store_dwordx2 v[104:105], v2, s[24:27], s78 offen sc1
    s_mov_b64 exec, -1
    s_lshr_b32 s22, s11, 2
    s_add_u32 m0, s22, 0
    s_mov_b32 s68, 0
    buffer_load_dwordx4 v16, s[44:47], s68 offen lds
    s_add_u32 m0, s22, 4096
    s_mov_b32 s68, 28672
    buffer_load_dwordx4 v16, s[44:47], s68 offen lds
    s_add_u32 m0, s22, 8192
    s_mov_b32 s68, 57344
    buffer_load_dwordx4 v16, s[44:47], s68 offen lds
    s_add_u32 m0, s22, 12288
    s_mov_b32 s68, 86016
    buffer_load_dwordx4 v16, s[44:47], s68 offen lds
    s_add_u32 m0, s22, 16384
    s_mov_b32 s68, 114688
    buffer_load_dwordx4 v16, s[44:47], s68 offen lds
    s_add_u32 m0, s22, 20480
    s_mov_b32 s68, 143360
    buffer_load_dwordx4 v16, s[44:47], s68 offen lds
    s_and_b32 s3, s76, 1
    s_lshl_b32 s12, s62, 1
    s_add_u32 s12, s12, s3
    s_lshr_b32 s77, s76, 1
    s_lshl_b32 s3, s12, 1
    s_add_u32 s3, s3, s77
    s_lshl_b32 s14, s3, 10
    s_add_u32 s14, s14, 14843904
    s_mul_i32 s13, s3, 14336
    s_add_u32 s13, s13, 5505024
    s_lshl_b32 s78, s63, 7
    s_lshl_b32 s3, s77, 6
    s_add_u32 s78, s78, s3
    s_mul_i32 s3, s12, 57344
    s_add_u32 s78, s78, s3
    s_waitcnt vmcnt(7)
    s_barrier
    s_mul_i32 s68, s10, 28672
    s_add_u32 m0, s11, 98304
    s_add_u32 s22, s68, s8
    s_add_u32 s22, s22, 9175040
    buffer_load_dwordx4 v2, s[24:27], s22 offen sc1 lds
    s_add_u32 s23, s22, 26624
    buffer_load_dwordx4 v2, s[24:27], s22 offen offset:1024 sc1 lds
    s_add_u32 s68, s68, s9
    buffer_load_dwordx4 v2, s[24:27], s23 offen offset:2048 sc1 lds
    s_add_u32 s68, s68, 11010048
    buffer_load_dwordx4 v2, s[24:27], s23 offen offset:3072 sc1 lds
    s_add_u32 m0, s11, 114688
    s_mov_b64 exec, s[66:67]
    buffer_load_dwordx4 v15, s[24:27], s68 offen offset:0 sc1 lds
    s_add_u32 s68, s68, 13312
    buffer_load_dwordx4 v15, s[24:27], s68 offen offset:1024 sc1 lds
    s_add_u32 s68, s68, 13312
    buffer_load_dwordx4 v15, s[24:27], s68 offen offset:2048 sc1 lds
    s_add_u32 s68, s68, 13312
    buffer_load_dwordx4 v15, s[24:27], s68 offen offset:3072 sc1 lds
    s_mov_b64 exec, -1
    s_add_u32 s10, s10, 8
    s_and_b32 s10, s10, 63
    s_lshr_b32 s22, s11, 2
    s_add_u32 m0, s22, 24576
    s_mov_b32 s68, 172032
    buffer_load_dwordx4 v16, s[44:47], s68 offen lds
    s_add_u32 m0, s22, 28672
    s_mov_b32 s68, 200704
    buffer_load_dwordx4 v16, s[44:47], s68 offen lds
    s_add_u32 m0, s22, 32768
    s_mov_b32 s68, 229376
    buffer_load_dwordx4 v16, s[44:47], s68 offen lds
    s_add_u32 m0, s22, 36864
    s_mov_b32 s68, 258048
    buffer_load_dwordx4 v16, s[44:47], s68 offen lds
    s_add_u32 m0, s22, 40960
    s_mov_b32 s68, 286720
    buffer_load_dwordx4 v16, s[44:47], s68 offen lds
    s_add_u32 m0, s22, 45056
    s_mov_b32 s68, 315392
    buffer_load_dwordx4 v16, s[44:47], s68 offen lds
    s_add_u32 m0, s22, 49152
    s_mov_b32 s68, 344064
    buffer_load_dwordx4 v16, s[44:47], s68 offen lds
    s_add_u32 m0, s22, 53248
    s_mov_b32 s68, 372736
    buffer_load_dwordx4 v16, s[44:47], s68 offen lds
    buffer_load_dwordx2 v[166:167], v18, s[24:27], s14 offen sc1
    s_waitcnt vmcnt(9)
    s_barrier
    s_waitcnt vmcnt(0)
    v_cmp_ne_u64 vcc, s[64:65], v[166:167]
    s_cmp_eq_u64 vcc, 0
    s_cbranch_scc1 H_ok2
    s_mov_b32 s79, 262144
poll_13:
    buffer_load_dwordx2 v[166:167], v18, s[24:27], s14 offen sc1
    s_waitcnt vmcnt(0)
    v_cmp_ne_u64 vcc, s[64:65], v[166:167]
    s_sub_u32 s79, s79, 1
    s_cbranch_scc1 poll_13_x
    s_cmp_eq_u64 vcc, 0
    s_cbranch_scc1 poll_13_x
    s_mov_b64 exec, vcc
    s_sleep 1
    s_branch poll_13
poll_13_x:
    s_mov_b64 exec, -1
H_ok2:
    s_lshl_b32 s3, s76, 2
    s_add_u32 s3, s3, 94208
    v_mov_b32 v160, s3
    v_xor_b32 v161, 8, v160
    v_mov_b32 v163, 94208
    v_mov_b32 v162, 0
    s_mov_b64 exec, 1
    ds_write_b32 v160, v162
    s_mov_b64 exec, -1
    s_lshr_b32 s22, s11, 2
    s_add_u32 m0, s22, 65536
    s_mov_b32 s68, 0
    buffer_load_dwordx4 v16, s[40:43], s68 offen lds
    s_add_u32 m0, s22, 69632
    s_mov_b32 s68, 28672
    buffer_load_dwordx4 v16, s[40:43], s68 offen lds
    s_add_u32 m0, s22, 73728
    s_mov_b32 s68, 57344
    buffer_load_dwordx4 v16, s[40:43], s68 offen lds
    s_add_u32 m0, s22, 77824
    s_mov_b32 s68, 86016
    buffer_load_dwordx4 v16, s[40:43], s68 offen lds
    s_add_u32 m0, s22, 81920
    s_mov_b32 s68, 114688
    buffer_load_dwordx4 v16, s[40:43], s68 offen lds
    s_add_u32 m0, s22, 86016
    s_mov_b32 s68, 143360
    buffer_load_dwordx4 v16, s[40:43], s68 offen lds
    s_add_u32 m0, s22, 90112
    s_mov_b32 s68, 172032
    buffer_load_dwordx4 v16, s[40:43], s68 offen lds
    buffer_load_dwordx4 v[28:31], v2, s[24:27], s13 offen offset:0 sc1
    buffer_load_dwordx4 v[32:35], v2, s[24:27], s13 offen offset:1024 sc1
    buffer_load_dwordx4 v[36:39], v2, s[24:27], s13 offen offset:2048 sc1
    buffer_load_dwordx4 v[40:43], v2, s[24:27], s13 offen offset:3072 sc1
    s_add_u32 s13, s13, 4096
    buffer_load_dwordx4 v[44:47], v2, s[24:27], s13 offen offset:0 sc1
    buffer_load_dwordx4 v[48:51], v2, s[24:27], s13 offen offset:1024 sc1
    buffer_load_dwordx4 v[52:55], v2, s[24:27], s13 offen offset:2048 sc1
    buffer_load_dwordx4 v[56:59], v2, s[24:27], s13 offen offset:3072 sc1
    s_add_u32 s13, s13, 4096
    buffer_load_dwordx4 v[60:63], v2, s[24:27], s13 offen offset:0 sc1
    s_waitcnt lgkmcnt(0)
    s_barrier
    s_lshr_b32 s22, s11, 2
    s_add_u32 m0, s22, 131072
    s_mov_b32 s68, 200704
    buffer_load_dwordx4 v16, s[40:43], s68 offen lds
    s_add_u32 m0, s22, 135168
    s_mov_b32 s68, 229376
    buffer_load_dwordx4 v16, s[40:43], s68 offen lds
    s_add_u32 m0, s22, 139264
    s_mov_b32 s68, 258048
    buffer_load_dwordx4 v16, s[40:43], s68 offen lds
    s_add_u32 m0, s22, 143360
    s_mov_b32 s68, 286720
    buffer_load_dwordx4 v16, s[40:43], s68 offen lds
    s_add_u32 m0, s22, 147456
    s_mov_b32 s68, 315392
    buffer_load_dwordx4 v16, s[40:43], s68 offen lds
    s_add_u32 m0, s22, 151552
    s_mov_b32 s68, 344064
    buffer_load_dwordx4 v16, s[40:43], s68 offen lds
    s_add_u32 m0, s22, 155648
    s_mov_b32 s68, 372736
    buffer_load_dwordx4 v16, s[40:43], s68 offen lds
    buffer_load_dwordx4 v[64:67], v2, s[24:27], s13 offen offset:1024 sc1
    buffer_load_dwordx4 v[68:71], v2, s[24:27], s13 offen offset:2048 sc1
    buffer_load_dwordx4 v[72:75], v2, s[24:27], s13 offen offset:3072 sc1
    s_add_u32 s13, s13, 4096
    buffer_load_dwordx4 v[76:79], v2, s[24:27], s13 offen offset:0 sc1
    buffer_load_dwordx4 v[80:83], v2, s[24:27], s13 offen offset:1024 sc1
    s_barrier
    s_cmp_ge_u32 s54, 28
    s_cbranch_scc1 H_idle
    s_setprio 2
    s_waitcnt vmcnt(5)
    v_mov_b32 v162, 1
    s_mov_b64 exec, 1
    ds_write_b32 v160, v162
    s_mov_b32 s23, 2097152
H_pv:
    ds_read_b128 v[164:167], v163
    s_waitcnt lgkmcnt(0)
    v_min3_u32 v164, v164, v165, v166
    v_min_u32 v164, v164, v167
    s_nop 0
    v_readfirstlane_b32 s3, v164
    s_sub_u32 s23, s23, 1
    s_cbranch_scc1 H_pvx
    s_cmp_lt_u32 s3, 1
    s_cbranch_scc1 H_pv
H_pvx:
    s_mov_b64 exec, -1
    ds_read_b64_tr_b16 v[116:117], v19 offset:0
    ds_read_b64_tr_b16 v[118:119], v19 offset:512
    ds_read_b64_tr_b16 v[120:121], v20 offset:0
    ds_read_b64_tr_b16 v[122:123], v20 offset:512
    ds_read_b64_tr_b16 v[124:125], v19 offset:2048
    ds_read_b64_tr_b16 v[126:127], v19 offset:2560
    ds_read_b64_tr_b16 v[128:129], v20 offset:2048
    ds_read_b64_tr_b16 v[130:131], v20 offset:2560
    ds_read_b64_tr_b16 v[132:133], v19 offset:4096
    ds_read_b64_tr_b16 v[134:135], v19 offset:4608
    ds_read_b64_tr_b16 v[136:137], v20 offset:4096
    ds_read_b64_tr_b16 v[138:139], v20 offset:4608
    s_waitcnt lgkmcnt(8)
    v_mfma_f32_32x32x16_bf16 v[84:99], v[116:119], v[28:31], 0
    v_mfma_f32_32x32x16_bf16 v[100:115], v[120:123], v[28:31], 0
    ds_read_b64_tr_b16 v[140:141], v19 offset:6144
    ds_read_b64_tr_b16 v[142:143], v19 offset:6656
    ds_read_b64_tr_b16 v[144:145], v20 offset:6144
    ds_read_b64_tr_b16 v[146:147], v20 offset:6656
    s_waitcnt lgkmcnt(8)
    v_mfma_f32_32x32x16_bf16 v[84:99], v[124:127], v[32:35], v[84:99]
    v_mfma_f32_32x32x16_bf16 v[100:115], v[128:131], v[32:35], v[100:115]
    ds_read_b64_tr_b16 v[116:117], v19 offset:8192
    ds_read_b64_tr_b16 v[118:119], v19 offset:8704
    ds_read_b64_tr_b16 v[120:121], v20 offset:8192
    ds_read_b64_tr_b16 v[122:123], v20 offset:8704
    s_waitcnt lgkmcnt(8)
    v_mfma_f32_32x32x16_bf16 v[84:99], v[132:135], v[36:39], v[84:99]
    v_mfma_f32_32x32x16_bf16 v[100:115], v[136:139], v[36:39], v[100:115]
    ds_read_b64_tr_b16 v[124:125], v19 offset:10240
    ds_read_b64_tr_b16 v[126:127], v19 offset:10752
    ds_read_b64_tr_b16 v[128:129], v20 offset:10240
    ds_read_b64_tr_b16 v[130:131], v20 offset:10752
    s_waitcnt lgkmcnt(8)
    v_mfma_f32_32x32x16_bf16 v[84:99], v[140:143], v[40:43], v[84:99]
    v_mfma_f32_32x32x16_bf16 v[100:115], v[144:147], v[40:43], v[100:115]
    ds_read_b64_tr_b16 v[132:133], v19 offset:12288
    ds_read_b64_tr_b16 v[134:135], v19 offset:12800
    ds_read_b64_tr_b16 v[136:137], v20 offset:12288
    ds_read_b64_tr_b16 v[138:139], v20 offset:12800
    s_waitcnt lgkmcnt(8)
    v_mfma_f32_32x32x16_bf16 v[84:99], v[116:119], v[44:47], v[84:99]
    v_mfma_f32_32x32x16_bf16 v[100:115], v[120:123], v[44:47], v[100:115]
    ds_read_b64_tr_b16 v[140:141], v19 offset:14336
    ds_read_b64_tr_b16 v[142:143], v19 offset:14848
    ds_read_b64_tr_b16 v[144:145], v20 offset:14336
    ds_read_b64_tr_b16 v[146:147], v20 offset:14848
    s_waitcnt lgkmcnt(8)
    v_mfma_f32_32x32x16_bf16 v[84:99], v[124:127], v[48:51], v[84:99]
    v_mfma_f32_32x32x16_bf16 v[100:115], v[128:131], v[48:51], v[100:115]
    ds_read_b64_tr_b16 v[116:117], v19 offset:16384
    ds_read_b64_tr_b16 v[118:119], v19 offset:16896
    ds_read_b64_tr_b16 v[120:121], v20 offset:16384
    ds_read_b64_tr_b16 v[122:123], v20 offset:16896
    s_waitcnt lgkmcnt(8)
    v_mfma_f32_32x32x16_bf16 v[84:99], v[132:135], v[52:55], v[84:99]
    v_mfma_f32_32x32x16_bf16 v[100:115], v[136:139], v[52:55], v[100:115]
    ds_read_b64_tr_b16 v[124:125], v19 offset:18432
    ds_read_b64_tr_b16 v[126:127], v19 offset:18944
    ds_read_b64_tr_b16 v[128:129], v20 offset:18432
    ds_read_b64_tr_b16 v[130:131], v20 offset:18944
    s_waitcnt lgkmcnt(8)
    v_mfma_f32_32x32x16_bf16 v[84:99], v[140:143], v[56:59], v[84:99]
    v_mfma_f32_32x32x16_bf16 v[100:115], v[144:147], v[56:59], v[100:115]
    ds_read_b64_tr_b16 v[132:133], v19 offset:20480
    ds_read_b64_tr_b16 v[134:135], v19 offset:20992
    ds_read_b64_tr_b16 v[136:137], v20 offset:20480
    ds_read_b64_tr_b16 v[138:139], v20 offset:20992
    s_waitcnt lgkmcnt(8)
    v_mfma_f32_32x32x16_bf16 v[84:99], v[116:119], v[60:63], v[84:99]
    v_mfma_f32_32x32x16_bf16 v[100:115], v[120:123], v[60:63], v[100:115]
    ds_read_b64_tr_b16 v[140:141], v19 offset:22528
    ds_read_b64_tr_b16 v[142:143], v19 offset:23040
    ds_read_b64_tr_b16 v[144:145], v20 offset:22528
    ds_read_b64_tr_b16 v[146:147], v20 offset:23040
    s_waitcnt vmcnt(4) lgkmcnt(8)
    v_mfma_f32_32x32x16_bf16 v[84:99], v[124:127], v[64:67], v[84:99]
    v_mfma_f32_32x32x16_bf16 v[100:115], v[128:131], v[64:67], v[100:115]
    ds_read_b64_tr_b16 v[116:117], v19 offset:24576
    ds_read_b64_tr_b16 v[118:119], v19 offset:25088
    ds_read_b64_tr_b16 v[120:121], v20 offset:24576
    ds_read_b64_tr_b16 v[122:123], v20 offset:25088
    s_waitcnt vmcnt(3) lgkmcnt(8)
    v_mfma_f32_32x32x16_bf16 v[84:99], v[132:135], v[68:71], v[84:99]
    v_mfma_f32_32x32x16_bf16 v[100:115], v[136:139], v[68:71], v[100:115]
    ds_read_b64_tr_b16 v[124:125], v19 offset:26624
    ds_read_b64_tr_b16 v[126:127], v19 offset:27136
    ds_read_b64_tr_b16 v[128:129], v20 offset:26624
    ds_read_b64_tr_b16 v[130:131], v20 offset:27136
    s_waitcnt vmcnt(2) lgkmcnt(8)
    v_mfma_f32_32x32x16_bf16 v[84:99], v[140:143], v[72:75], v[84:99]
    v_mfma_f32_32x32x16_bf16 v[100:115], v[144:147], v[72:75], v[100:115]
    s_waitcnt vmcnt(1) lgkmcnt(4)
    v_mfma_f32_32x32x16_bf16 v[84:99], v[116:119], v[76:79], v[84:99]
    v_mfma_f32_32x32x16_bf16 v[100:115], v[120:123], v[76:79], v[100:115]
    s_waitcnt vmcnt(0) lgkmcnt(0)
    v_mfma_f32_32x32x16_bf16 v[84:99], v[124:127], v[80:83], v[84:99]
    v_mfma_f32_32x32x16_bf16 v[100:115], v[128:131], v[80:83], v[100:115]
    s_cmp_eq_u32 s77, 0
    s_nop 10
    s_cbranch_scc1 H_y0
    ds_write_b128 v22, v[84:87] offset:0
    ds_write_b128 v22, v[88:91] offset:1024
    ds_write_b128 v22, v[92:95] offset:2048
    ds_write_b128 v22, v[96:99] offset:3072
    s_branch H_y1
H_y0:
    ds_write_b128 v22, v[100:103] offset:0
    ds_write_b128 v22, v[104:107] offset:1024
    ds_write_b128 v22, v[108:111] offset:2048
    ds_write_b128 v22, v[112:115] offset:3072
H_y1:
    s_waitcnt lgkmcnt(0)
    v_mov_b32 v162, 2
    s_mov_b64 exec, 1
    ds_write_b32 v160, v162
    s_mov_b32 s23, 2097152
H_pw:
    ds_read_b32 v164, v161
    s_waitcnt lgkmcnt(0)
    v_readfirstlane_b32 s3, v164
    s_sub_u32 s23, s23, 1
    s_cbranch_scc1 H_pwx
    s_cmp_lt_u32 s3, 2
    s_cbranch_scc1 H_pw
H_pwx:
    s_mov_b64 exec, -1
    s_cmp_eq_u32 s77, 0
    ds_read_b128 v[28:31], v23 offset:0
    ds_read_b128 v[32:35], v23 offset:1024
    ds_read_b128 v[36:39], v23 offset:2048
    ds_read_b128 v[40:43], v23 offset:3072
    s_waitcnt lgkmcnt(0)
    s_cbranch_scc1 H_z0
    v_add_f32 v28, v100, v28
    v_add_f32 v29, v101, v29
    v_add_f32 v30, v102, v30
    v_add_f32 v31, v103, v31
    v_add_f32 v32, v104, v32
    v_add_f32 v33, v105, v33
    v_add_f32 v34, v106, v34
    v_add_f32 v35, v107, v35
    v_add_f32 v36, v108, v36
    v_add_f32 v37, v109, v37
    v_add_f32 v38, v110, v38
    v_add_f32 v39, v111, v39
    v_add_f32 v40, v112, v40
    v_add_f32 v41, v113, v41
    v_add_f32 v42, v114, v42
    v_add_f32 v43, v115, v43
    s_branch H_z1
H_z0:
    v_add_f32 v28, v84, v28
    v_add_f32 v29, v85, v29
    v_add_f32 v30, v86, v30
    v_add_f32 v31, v87, v31
    v_add_f32 v32, v88, v32
    v_add_f32 v33, v89, v33
    v_add_f32 v34, v90, v34
    v_add_f32 v35, v91, v35
    v_add_f32 v36, v92, v36
    v_add_f32 v37, v93, v37
    v_add_f32 v38, v94, v38
    v_add_f32 v39, v95, v39
    v_add_f32 v40, v96, v40
    v_add_f32 v41, v97, v41
    v_add_f32 v42, v98, v42
    v_add_f32 v43, v99, v43
H_z1:
    v_cvt_pk_bf16_f32 v28, v28, v29
    v_cvt_pk_bf16_f32 v29, v30, v31
    v_cvt_pk_bf16_f32 v30, v32, v33
    v_cvt_pk_bf16_f32 v31, v34, v35
    v_cvt_pk_bf16_f32 v32, v36, v37
    v_cvt_pk_bf16_f32 v33, v38, v39
    v_cvt_pk_bf16_f32 v34, v40, v41
    v_cvt_pk_bf16_f32 v35, v42, v43
    s_nop 1
    v_permlane32_swap_b32 v28, v30
    v_permlane32_swap_b32 v29, v31
    v_permlane32_swap_b32 v32, v34
    v_permlane32_swap_b32 v33, v35
    buffer_store_dwordx4 v[28:31], v21, s[36:39], s78 offen nt
    buffer_store_dwordx4 v[32:35], v21, s[36:39], s78 offen offset:32 nt
    s_barrier
H_exit:
    s_endpgm
H_idle:
    s_cmp_lg_u32 s2, 255
    s_cbranch_scc1 H_exit
    s_cmp_lg_u32 s52, 4
    s_cbranch_scc1 H_exit
    v_lshlrev_b32 v160, 7, v0
    s_mov_b32 s79, 262144
H_ep:
    s_mov_b32 s3, 14680064
    buffer_load_dwordx2 v[28:29], v160, s[24:27], s3 offen sc1
    s_mov_b32 s3, 14688256
    buffer_load_dwordx2 v[30:31], v160, s[24:27], s3 offen sc1
    s_mov_b32 s3, 14696448
    buffer_load_dwordx2 v[32:33], v160, s[24:27], s3 offen sc1
    s_mov_b32 s3, 14704640
    buffer_load_dwordx2 v[34:35], v160, s[24:27], s3 offen sc1
    s_waitcnt vmcnt(0)
    s_mov_b64 s[4:5], 0
    v_cmp_ne_u64 vcc, s[64:65], v[28:29]
    s_or_b64 s[4:5], s[4:5], vcc
    v_cmp_ne_u64 vcc, s[64:65], v[30:31]
    s_or_b64 s[4:5], s[4:5], vcc
    v_cmp_ne_u64 vcc, s[64:65], v[32:33]
    s_or_b64 s[4:5], s[4:5], vcc
    v_cmp_ne_u64 vcc, s[64:65], v[34:35]
    s_or_b64 s[4:5], s[4:5], vcc
    s_sub_u32 s79, s79, 1
    s_cbranch_scc1 H_epx
    s_cmp_lg_u64 s[4:5], 0
    s_cbranch_scc1 H_ep
H_epx:
    v_mov_b32 v160, 14974976
    v_mov_b32 v161, s64
    s_mov_b64 exec, 1
    buffer_store_dword v161, v160, s[24:27], 0 offen sc1
    s_mov_b64 exec, -1
    s_branch H_exit
L_end:
    s_endpgm
    .p2align 4
L_ones:
    .long 0x3f803f80, 0x3f803f80, 0x3f803f80, 0x3f803f80
L_code_end:
.section .rodata,"a"
.p2align 6
.amdhsa_kernel concat_heads__sliding_local_dilated__mha_block__prompt_kernel
  .amdhsa_next_free_vgpr 168
  .amdhsa_next_free_sgpr 102
  .amdhsa_accum_offset 168
  .amdhsa_group_segment_fixed_size 0
  .amdhsa_kernarg_size 72
  .amdhsa_user_sgpr_count 2
  .amdhsa_user_sgpr_kernarg_segment_ptr 1
  .amdhsa_system_sgpr_workgroup_id_x 1
.end_amdhsa_kernel
```
